```python
import torch

def _softmax(x, axis=-1):
    return torch.softmax(x, dim=axis)
def _gelu(x):
    return torch.nn.functional.gelu(x, approximate="tanh")
def _silu(x):
    return torch.nn.functional.silu(x)
def _sigmoid(x):
    return torch.sigmoid(x)
def _layernorm(x, axis=-1, eps=1e-5):
    m = x.mean(dim=axis, keepdim=True)
    v = x.var(dim=axis, keepdim=True, unbiased=False)
    return (x - m) / torch.sqrt(v + eps)
def _scatter_add(tgt, idx, src, axis=0):
    return tgt.clone().index_add_(axis, idx, src)
def _segment_sum(src, seg, n):
    out = torch.zeros((n,) + src.shape[1:], dtype=src.dtype)
    return out.index_add_(0, seg, src)
def _pad(x, pw):
    flat = tuple(v for pair in reversed(pw) for v in pair)
    return torch.nn.functional.pad(x, flat)

kernel_name = 'standalone__gqa_block_cached__near_ridge'

def setup_inputs():

    _w = (lambda a: (lambda t: t.to(torch.bfloat16) if t.is_floating_point() else t)(torch.as_tensor(a)))
    B, Sq, D = 16, 32, 512
    Hq, Hkv, Sk, Dh = 32, 8, 512, 128
    assert Hq % Hkv == 0, (Hq, Hkv)
    return {
        "x": _w((lambda *s: torch.randn(*s, dtype=torch.bfloat16) * 0.8)(B, Sq, D)),
        "k_cache": _w((lambda *s: torch.randn(*s, dtype=torch.bfloat16) * 0.8)(B, Hkv, Sk, Dh)),
        "v_cache": _w((lambda *s: torch.randn(*s, dtype=torch.bfloat16) * 0.05)(B, Hkv, Sk, Dh)),
        "wq": _w((lambda *s: torch.randn(*s, dtype=torch.bfloat16) * 0.8)(D, Hq * Dh) * (D ** -0.5)),
        "wo": _w((lambda *s: torch.randn(*s, dtype=torch.bfloat16) * 0.05)(Hq * Dh, D) * ((Hq * Dh) ** -0.5)),
    }

def reference(x, k_cache, v_cache, wq, wo):
    B, Sq, D = x.shape
    Hq, Dh = 32, 128
    Hkv = k_cache.shape[1]
    rep = Hq // Hkv
    q = (lambda x, *d: x.permute(*d))((x @ wq).reshape(B, Sq, Hq, Dh), 0, 2, 1, 3)
    k = (lambda x, n, axis: torch.repeat_interleave(x, n, dim=axis))(k_cache, rep, axis=1)
    v = (lambda x, n, axis: torch.repeat_interleave(x, n, dim=axis))(v_cache, rep, axis=1)
    scores = torch.einsum("bhqd,bhkd->bhqk", q, k) * (Dh ** -0.5)
    p = _softmax(scores, axis=-1)
    o = torch.einsum("bhqk,bhkd->bhqd", p, v)
    return (lambda x, *d: x.permute(*d))(o, 0, 2, 1, 3).reshape(B, Sq, Hq * Dh) @ wo
```

```asm
; @launch grid=(256,1,1) block=(512,1,1) lds=154304
.amdgcn_target "amdgcn-amd-amdhsa--gfx950"
.text
.globl standalone__gqa_block_cached__near_ridge_kernel
.p2align 12
.type standalone__gqa_block_cached__near_ridge_kernel,@function
standalone__gqa_block_cached__near_ridge_kernel:
    s_load_dwordx16 s[4:19], s[0:1], 0
    s_cmp_ge_u32 s2, 256
    s_cbranch_scc1 L_main_end
    v_lshrrev_b32 v5, 6, v0
    v_and_b32 v0, 63, v0
    v_readfirstlane_b32 s48, v5
    s_xor_b32 s48, s48, 4
    s_and_b32 s50, s2, 7
    s_lshr_b32 s51, s2, 4
    s_bfe_u32 s52, s2, 0x10003
    s_lshl_b32 s53, s50, 1
    s_add_u32 s53, s53, s52
    s_mov_b32 s54, s51
    s_and_b32 s49, s48, 3
    s_mov_b32 s68, 400000
    s_mul_i32 s55, s48, 528
    s_add_u32 s55, s55, 147456
    v_lshl_add_u32 v1, v0, 2, s55
    v_and_b32 v2, 3, v0
    v_mul_u32_u24 v2, 528, v2
    v_add_u32 v2, 147456, v2
    v_mov_b32 v3, 1
    v_mov_b32 v4, 1
    s_cmp_lt_u32 s48, 6
    s_cselect_b32 s59, 1, 0
    v_mov_b32 v5, s59
    ds_write_b32 v1, v5
    v_mov_b32 v5, 0
    s_and_b32 s59, s48, 6
    s_cmp_eq_u32 s59, 4
    s_cbranch_scc0 L_other
L_ld2:
    s_lshl_b32 s49, s49, 1
    s_setprio 3
    s_xor_b32 s59, s49, s54
    s_lshl_b32 s59, s59, 2
    v_xor_b32 v7, s59, v0
    v_lshlrev_b32 v32, 4, v7
    v_xor_b32 v33, 16, v32
    v_xor_b32 v34, 32, v32
    v_xor_b32 v35, 48, v32
    v_xor_b32 v36, 64, v32
    v_xor_b32 v37, 80, v32
    v_xor_b32 v38, 96, v32
    v_xor_b32 v39, 112, v32
    s_lshl_b32 s60, s49, 12
    s_mov_b32 s61, s60
    s_add_u32 s56, s60, 147456
    s_add_u32 s62, s55, 248
    v_add_u32 v8, 284, v2
G_3:
    s_cbranch_execz G_5
    v_mov_b32 v4, 0
    s_lshl_b32 s66, s51, 15
    s_add_u32 s66, s66, s60
    s_mov_b32 s63, 0
    s_mov_b32 s64, 16384
    s_mov_b32 s67, 4096
    s_mov_b32 s70, 1
    s_mov_b32 s23, 0x20000
    s_mov_b32 s75, 0x20000
    s_mov_b32 s74, 256
    s_mov_b32 s22, 524288
    s_waitcnt lgkmcnt(0)
    s_mov_b32 s72, s16
    s_mov_b32 s73, s17
    s_mov_b32 s20, s4
    s_mov_b32 s21, s5
    s_call_b64 s[30:31], L_seg
    s_branch L_ld3
L_poll:
    ds_read_b32 v4, v8
    s_sub_u32 s68, s68, 1
    s_cbranch_scc1 L_main_end
L_seg:
    s_waitcnt lgkmcnt(0)
    v_cmp_ne_u32 vcc, 0, v4
    s_xor_b32 s59, s66, s63
    s_mov_b32 m0, s61
    s_cbranch_vccnz L_poll
    s_waitcnt vmcnt(18)
    buffer_load_dwordx4 v32, s[20:23], s59 offen offset:0 lds
    buffer_load_dwordx4 v33, s[20:23], s59 offen offset:1024 lds
    s_waitcnt vmcnt(18)
    buffer_load_dwordx4 v34, s[20:23], s59 offen offset:2048 lds
    buffer_load_dwordx4 v35, s[20:23], s59 offen offset:3072 lds
    s_add_u32 s59, s59, s67
    s_add_u32 m0, s61, 4096
    s_waitcnt vmcnt(18)
    buffer_load_dwordx4 v36, s[20:23], s59 offen offset:0 lds
    buffer_load_dwordx4 v37, s[20:23], s59 offen offset:1024 lds
    s_waitcnt vmcnt(18)
    buffer_load_dwordx4 v38, s[20:23], s59 offen offset:2048 lds
    buffer_load_dwordx4 v39, s[20:23], s59 offen offset:3072 lds
    s_mov_b32 m0, s62
    v_subrev_u32 v8, 4, v8
    buffer_load_dword off, s[72:75], 0 lds
    ds_read_b32 v4, v8
G_4:
    s_cbranch_execz G_6
    s_add_u32 s63, s63, s64
    s_sub_u32 s62, s62, 4
    s_add_u32 s61, s61, 16384
    s_cmp_ge_u32 s61, s56
    s_cselect_b32 s61, s60, s61
    s_sub_u32 s70, s70, 1
    s_cbranch_scc0 L_seg
    s_setpc_b64 s[30:31]
L_other:
    s_cmp_lt_u32 s48, 4
    s_cbranch_scc0 L_walker
    ds_write_b32 v1, v5 offset:252
    ds_write_b32 v1, v5 offset:4224
    s_branch L_compute
L_walker:
    v_lshlrev_b32 v6, 2, v0
    v_add_u32 v6, 153792, v6
    ds_write_b32 v6, v5
    ds_write_b32 v6, v3 offset:256
    s_waitcnt lgkmcnt(0)
    s_lshl_b32 s60, s51, 15
    s_add_u32 s60, s60, 33554432
    s_lshl_b32 s59, s53, 11
    s_add_u32 s60, s60, s59
    s_load_dword s82, s[18:19], s60 glc
    s_barrier
    s_mov_b64 exec, 0
    s_getreg_b32 s57, hwreg(HW_REG_HW_ID, 8, 1)
    s_cmp_eq_u32 s57, 0
    s_cbranch_scc1 L_warm_go
    s_cmp_eq_u32 s49, 2
    s_cbranch_scc1 G_40
    s_cmp_eq_u32 s49, 3
    s_cbranch_scc1 G_41
L_warm_go:
    s_mov_b32 s57, 0
    s_cmp_eq_u32 s49, 2
    s_cbranch_scc1 G_0
    s_cmp_eq_u32 s49, 3
    s_cbranch_scc1 G_1
L_warm_ret:
    s_cmp_lg_u32 s57, 0
    s_cbranch_scc1 L_warm_go
    s_cmp_eq_u32 s49, 2
    s_cbranch_scc1 L_ofetch
    s_endpgm
L_ld3:
    v_lshrrev_b32 v30, 5, v0
    v_and_b32 v29, 31, v0
    v_add_u32 v7, 0, v30
    v_and_b32 v28, 3, v7
    v_lshlrev_b32 v28, 1, v28
    v_xor_b32 v28, v28, v29
    v_lshlrev_b32 v28, 4, v28
    v_lshl_add_u32 v32, v7, 13, v28
    v_add_u32 v7, 2, v30
    v_and_b32 v28, 3, v7
    v_lshlrev_b32 v28, 1, v28
    v_xor_b32 v28, v28, v29
G_5:
    s_cbranch_execz G_7
    v_lshlrev_b32 v28, 4, v28
    v_lshl_add_u32 v33, v7, 13, v28
    v_subrev_u32 v33, 1024, v33
    v_add_u32 v7, 4, v30
    v_and_b32 v28, 3, v7
    v_lshlrev_b32 v28, 1, v28
    v_xor_b32 v28, v28, v29
    v_lshlrev_b32 v28, 4, v28
    v_lshl_add_u32 v34, v7, 13, v28
    v_subrev_u32 v34, 2048, v34
    v_add_u32 v7, 6, v30
    v_and_b32 v28, 3, v7
    v_lshlrev_b32 v28, 1, v28
    v_xor_b32 v28, v28, v29
    v_lshlrev_b32 v28, 4, v28
    v_lshl_add_u32 v35, v7, 13, v28
    v_subrev_u32 v35, 3072, v35
    v_xor_b32 v36, 128, v32
    v_xor_b32 v37, 128, v33
    v_xor_b32 v38, 128, v34
    v_xor_b32 v39, 128, v35
    s_mov_b32 s20, s10
    s_mov_b32 s21, s11
    s_mov_b32 s22, 4194304
    s_lshl_b32 s66, s49, 16
    s_lshl_b32 s59, s53, 9
    s_add_u32 s66, s66, s59
    s_lshl_b32 s59, s54, 18
    s_add_u32 s66, s66, s59
    s_mov_b32 s63, 0
    s_mov_b32 s64, 262144
    s_mov_b32 s67, 65536
    s_mov_b32 s70, 15
    s_barrier
    s_call_b64 s[30:31], L_seg
    v_lshrrev_b32 v30, 4, v0
    v_and_b32 v29, 15, v0
    v_add_u32 v7, 0, v30
    v_xor_b32 v7, v7, v29
    v_lshlrev_b32 v7, 4, v7
    v_lshl_add_u32 v32, v30, 8, v7
    v_mov_b32 v36, v32
    v_add_u32 v7, 4, v30
    v_xor_b32 v7, v7, v29
    v_lshlrev_b32 v7, 4, v7
    v_lshl_add_u32 v33, v30, 8, v7
    v_mov_b32 v37, v33
    v_add_u32 v7, 8, v30
G_6:
    s_cbranch_execz G_8
    v_xor_b32 v7, v7, v29
    v_lshlrev_b32 v7, 4, v7
    v_lshl_add_u32 v34, v30, 8, v7
    v_mov_b32 v38, v34
    v_add_u32 v7, 12, v30
    v_xor_b32 v7, v7, v29
    v_lshlrev_b32 v7, 4, v7
    v_lshl_add_u32 v35, v30, 8, v7
    v_mov_b32 v39, v35
    s_mov_b32 s20, s6
    s_mov_b32 s21, s7
    s_mov_b32 s22, 16777216
    s_lshl_b32 s66, s51, 3
    s_add_u32 s66, s66, s50
    s_lshl_b32 s66, s66, 17
    s_add_u32 s66, s66, s60
    s_mov_b32 s63, 0
    s_mov_b32 s64, 16384
    s_mov_b32 s67, 4096
    s_mov_b32 s70, 7
    s_call_b64 s[30:31], L_seg
    v_lshlrev_b32 v7, 1, v30
    v_xor_b32 v7, v7, v29
    v_lshlrev_b32 v7, 4, v7
    v_lshl_add_u32 v32, v30, 8, v7
    v_xor_b32 v33, 128, v32
    v_xor_b32 v34, 0, v32
    v_xor_b32 v35, 128, v32
    v_xor_b32 v36, 0, v32
    v_xor_b32 v37, 128, v32
    v_xor_b32 v38, 0, v32
    v_xor_b32 v39, 128, v32
    s_mov_b32 s20, s8
    s_mov_b32 s21, s9
    s_mov_b32 s70, 7
    s_mov_b32 s63, 0
    s_call_b64 s[30:31], L_seg
    v_lshlrev_b32 v7, 2, v30
    v_xor_b32 v7, v7, v29
    v_lshlrev_b32 v7, 4, v7
    v_lshl_add_u32 v32, v30, 10, v7
    v_add_u32 v33, 3072, v32
    v_add_u32 v34, 6144, v32
    v_add_u32 v35, 9216, v32
    v_add_u32 v36, 0, v32
    v_add_u32 v37, 3072, v32
    v_add_u32 v38, 6144, v32
G_7:
    s_cbranch_execz G_9
    v_add_u32 v39, 9216, v32
    s_mov_b32 s20, s12
    s_mov_b32 s21, s13
    s_mov_b32 s22, 4194304
    s_lshr_b32 s92, s51, 3
    s_and_b32 s93, s51, 1
    s_lshl_b32 s93, s93, 1
    s_or_b32 s92, s92, s93
    s_xor_b32 s93, s92, 1
    s_lshl_b32 s57, s53, 18
    s_lshl_b32 s59, s49, 14
    s_add_u32 s57, s57, s59
    s_bfe_u32 s59, s51, 0x20001
    s_lshl_b32 s59, s59, 16
    s_add_u32 s57, s57, s59
    s_mov_b32 s64, 65536
    s_mov_b32 s67, 16384
    s_lshl_b32 s66, s92, 8
    s_add_u32 s66, s66, s57
    s_mov_b32 s63, 0
    s_mov_b32 s70, 3
    s_call_b64 s[30:31], L_seg
    s_lshl_b32 s66, s93, 8
    s_add_u32 s66, s66, s57
    s_mov_b32 s63, 0
    s_sub_u32 s62, s62, 4
    s_add_u32 s61, s61, 16384
    s_cmp_ge_u32 s61, s56
    s_cselect_b32 s61, s60, s61
    v_subrev_u32 v8, 4, v8
    s_waitcnt lgkmcnt(0)
    ds_read_b32 v4, v8
    s_mov_b32 s70, 0
    s_call_b64 s[30:31], L_seg
L_pause:
    ds_read_b32 v6, v2 offset:116
    s_sub_u32 s68, s68, 1
    s_cbranch_scc1 L_main_end
    s_waitcnt lgkmcnt(0)
    v_cmp_ne_u32 vcc, 0, v6
    s_cbranch_vccnz L_pause
    s_mov_b32 s70, 2
    s_call_b64 s[30:31], L_seg
    s_waitcnt vmcnt(0)
    s_cmp_eq_u32 s49, 2
    s_cbranch_scc1 L_vpoll
L_main_end:
    s_endpgm
L_ofetch:
    s_mov_b64 exec, -1
    s_mov_b32 s40, s18
    s_mov_b32 s41, s19
    s_mov_b32 s42, 268435456
    s_mov_b32 s43, 0x20000
    s_mov_b32 s72, s16
    s_mov_b32 s73, s17
G_8:
    s_cbranch_execz G_10
    s_mov_b32 s74, 256
    s_mov_b32 s75, 0x20000
    s_xor_b32 s59, s51, 1
    s_lshl_b32 s59, s59, 4
    s_add_u32 s59, s59, s53
    s_lshl_b32 s57, s59, 14
    s_add_u32 s57, s57, 25165824
    s_lshl_b32 s59, s59, 7
    s_add_u32 s59, s59, 35651584
    s_add_u32 s24, s18, s59
    s_addc_u32 s25, s19, 0
    v_lshlrev_b32 v10, 4, v0
L_pw:
    ds_read_b32 v4, v2 offset:124
    s_sub_u32 s68, s68, 1
    s_cbranch_scc1 L_main_end
    s_waitcnt lgkmcnt(0)
    v_cmp_ne_u32 vcc, 0, v4
    s_cbranch_vccnz L_pw
    ds_read_b32 v9, v2 offset:4480
    s_setprio 3
    s_waitcnt lgkmcnt(0)
    v_readfirstlane_b32 s56, v9
L_pf:
    s_load_dwordx4 s[32:35], s[24:25], 0 glc
    s_sub_u32 s68, s68, 1
    s_cbranch_scc1 L_main_end
    s_waitcnt lgkmcnt(0)
    s_xor_b32 s32, s32, s56
    s_xor_b32 s33, s33, s56
    s_xor_b32 s34, s34, s56
    s_xor_b32 s35, s35, s56
    s_or_b32 s32, s32, s33
    s_or_b32 s34, s34, s35
    s_or_b32 s32, s32, s34
    s_cbranch_scc1 L_pf
L_ps:
    ds_read_b32 v4, v2 offset:112
    s_sub_u32 s68, s68, 1
    s_cbranch_scc1 L_main_end
    s_waitcnt lgkmcnt(0)
    v_cmp_ne_u32 vcc, 0, v4
    s_cbranch_vccnz L_ps
    s_mov_b32 m0, 32768
    s_nop 0
    buffer_load_dwordx4 v10, s[40:43], s57 offen offset:0 sc1 lds
    buffer_load_dwordx4 v10, s[40:43], s57 offen offset:1024 sc1 lds
    buffer_load_dwordx4 v10, s[40:43], s57 offen offset:2048 sc1 lds
    buffer_load_dwordx4 v10, s[40:43], s57 offen offset:3072 sc1 lds
    s_mov_b32 m0, 36864
    s_add_u32 s57, s57, 4096
G_9:
    s_cbranch_execz G_11
    buffer_load_dwordx4 v10, s[40:43], s57 offen offset:0 sc1 lds
    buffer_load_dwordx4 v10, s[40:43], s57 offen offset:1024 sc1 lds
    buffer_load_dwordx4 v10, s[40:43], s57 offen offset:2048 sc1 lds
    buffer_load_dwordx4 v10, s[40:43], s57 offen offset:3072 sc1 lds
    s_mov_b32 m0, 40960
    s_add_u32 s57, s57, 4096
    buffer_load_dwordx4 v10, s[40:43], s57 offen offset:0 sc1 lds
    buffer_load_dwordx4 v10, s[40:43], s57 offen offset:1024 sc1 lds
    buffer_load_dwordx4 v10, s[40:43], s57 offen offset:2048 sc1 lds
    buffer_load_dwordx4 v10, s[40:43], s57 offen offset:3072 sc1 lds
    s_mov_b32 m0, 45056
    s_add_u32 s57, s57, 4096
    buffer_load_dwordx4 v10, s[40:43], s57 offen offset:0 sc1 lds
    buffer_load_dwordx4 v10, s[40:43], s57 offen offset:1024 sc1 lds
    buffer_load_dwordx4 v10, s[40:43], s57 offen offset:2048 sc1 lds
    buffer_load_dwordx4 v10, s[40:43], s57 offen offset:3072 sc1 lds
    s_mov_b32 m0, 154048
    s_nop 0
    buffer_load_dword off, s[72:75], 0 lds
    s_waitcnt vmcnt(0)
    s_endpgm
L_vpoll:
    s_setprio 0
    ds_read_b32 v9, v2 offset:4480
    s_mov_b32 s40, s18
    s_mov_b32 s41, s19
    s_mov_b32 s42, 268435456
    s_mov_b32 s43, 0x20000
    s_lshl_b32 s60, s51, 15
    s_add_u32 s60, s60, 33554432
    s_and_b32 s59, s53, 3
    s_mul_i32 s61, s59, 528
    s_lshl_b32 s59, s53, 11
    s_add_u32 s60, s60, s59
    s_add_u32 s61, s61, 151680
    v_add_u32 v11, 4224, v2
    v_and_b32 v10, 15, v0
    v_lshlrev_b32 v10, 7, v10
    v_lshlrev_b32 v12, 2, v0
G_10:
    s_cbranch_execz G_12
    v_add_u32 v12, 153792, v12
    s_lshr_b32 s59, s53, 3
    s_xor_b32 s59, s59, s51
    s_not_b32 s59, s59
    s_and_b32 s59, s59, 1
    s_lshl_b32 s62, s59, s53
    s_add_u32 s20, s18, s60
    s_addc_u32 s21, s19, 0
    s_waitcnt lgkmcnt(0)
    v_readfirstlane_b32 s56, v9
L_vp1:
    s_load_dwordx16 s[24:39], s[20:21], 0 glc
    s_sub_u32 s68, s68, 1
    s_cbranch_scc1 L_main_end
    s_waitcnt lgkmcnt(0)
    ds_read_b32 v14, v11
    s_mov_b32 s63, 0
    s_cmp_eq_u32 s39, s56
    s_addc_u32 s63, s63, s63
    s_cmp_eq_u32 s38, s56
    s_addc_u32 s63, s63, s63
    s_cmp_eq_u32 s37, s56
    s_addc_u32 s63, s63, s63
    s_cmp_eq_u32 s36, s56
    s_addc_u32 s63, s63, s63
    s_cmp_eq_u32 s35, s56
    s_addc_u32 s63, s63, s63
    s_cmp_eq_u32 s34, s56
    s_addc_u32 s63, s63, s63
    s_cmp_eq_u32 s33, s56
    s_addc_u32 s63, s63, s63
    s_cmp_eq_u32 s32, s56
    s_addc_u32 s63, s63, s63
    s_cmp_eq_u32 s31, s56
    s_addc_u32 s63, s63, s63
    s_cmp_eq_u32 s30, s56
    s_addc_u32 s63, s63, s63
    s_cmp_eq_u32 s29, s56
    s_addc_u32 s63, s63, s63
    s_cmp_eq_u32 s28, s56
    s_addc_u32 s63, s63, s63
    s_cmp_eq_u32 s27, s56
    s_addc_u32 s63, s63, s63
    s_cmp_eq_u32 s26, s56
    s_addc_u32 s63, s63, s63
    s_cmp_eq_u32 s25, s56
    s_addc_u32 s63, s63, s63
    s_cmp_eq_u32 s24, s56
    s_addc_u32 s63, s63, s63
    s_waitcnt lgkmcnt(0)
    v_cmp_eq_u32 vcc, 2, v14
    s_or_b32 s63, s63, s62
    s_cmp_eq_u32 vcc_lo, -1
    s_cselect_b32 s63, s63, 0
    s_lshr_b32 s64, s63, 1
    s_and_b32 s63, s63, s64
    s_and_b32 s63, s63, 0x5555
    v_mov_b32 v15, s63
    ds_write_b32 v12, v15
G_11:
    s_cbranch_execz G_13
    s_cmp_eq_u32 s63, 0x5555
    s_cbranch_scc0 L_vp1
    s_endpgm
.p2align 9
L_compute:
G_0:
    s_cbranch_execz G_2
    s_and_b32 s56, s49, 1
    s_lshr_b32 s57, s49, 1
    s_mov_b32 s58, 1040356334
    v_and_b32 v16, 15, v0
    v_lshrrev_b32 v17, 4, v0
    v_bfe_u32 v18, v0, 2, 2
    v_and_b32 v19, 3, v0
    v_xor_b32 v7, v16, v17
    v_lshlrev_b32 v7, 4, v7
    v_lshl_add_u32 v7, v16, 10, v7
    s_lshl_b32 s59, s56, 14
    v_add_u32 v20, s59, v7
    v_xor_b32 v21, 64, v20
    v_xor_b32 v22, 128, v20
    v_xor_b32 v23, 192, v20
    v_bfe_u32 v5, v0, 2, 3
    v_lshlrev_b32 v6, 5, v5
    v_lshl_add_u32 v6, v19, 3, v6
    v_lshl_add_u32 v7, v17, 3, v18
    v_lshl_add_u32 v7, v7, 9, v6
    s_lshl_b32 s59, s57, 8
    v_add_u32 v8, s59, v7
    v_xor_b32 v9, 32, v8
    v_xor_b32 v10, 64, v8
    v_xor_b32 v11, 96, v8
    v_xor_b32 v12, 128, v8
    v_xor_b32 v13, 160, v8
    v_xor_b32 v14, 192, v8
    v_xor_b32 v15, 224, v8
    s_mov_b32 m0, s55
    s_waitcnt lgkmcnt(0)
    s_barrier
    s_mov_b32 s72, s16
    s_mov_b32 s73, s17
    s_mov_b32 s74, 256
    s_mov_b32 s75, 0x20000
    s_mov_b32 s40, s18
    s_mov_b32 s41, s19
    s_mov_b32 s42, 268435456
    s_mov_b32 s43, 0x20000
    s_and_b32 s69, s51, 14
    s_lshl_b32 s69, s69, 8
    s_add_u32 s69, s69, 37748736
    buffer_load_dword v118, off, s[40:43], s69 sc1
G_1:
    s_cbranch_execz G_3
    v_lshrrev_b32 v7, 2, v0
    v_lshl_add_u32 v114, v7, 8, v6
    v_bfe_u32 v5, v0, 4, 1
    v_lshrrev_b32 v7, 5, v0
    v_lshl_add_u32 v5, v5, 1, v7
    v_xor_b32 v5, v5, v16
    v_lshlrev_b32 v5, 4, v5
    v_lshl_add_u32 v113, v16, 8, v5
    v_lshl_add_u32 v5, v7, 2, v18
    v_lshlrev_b32 v5, 8, v5
    v_xor_b32 v6, s49, v18
    v_lshl_add_u32 v5, v6, 6, v5
    v_and_b32 v6, 1, v19
    v_lshl_add_u32 v5, v6, 5, v5
    v_bfe_u32 v6, v0, 4, 1
    v_lshl_add_u32 v5, v6, 4, v5
    v_lshrrev_b32 v17, 1, v19
    v_lshl_add_u32 v123, v17, 3, v5
    v_lshl_add_u32 v5, v6, 5, v16
    v_lshlrev_b32 v5, 4, v5
    v_lshl_add_u32 v5, v7, 10, v5
    s_lshl_b32 s59, s57, 13
    s_lshl_b32 s60, s56, 8
    s_add_u32 s59, s59, s60
    s_add_u32 s59, s59, 32768
    v_add_u32 v117, s59, v5
    v_lshlrev_b32 v116, 4, v0
    v_mov_b32 v104, 0x3f803f80
    v_mov_b32 v105, 0x3f803f80
    v_mov_b32 v106, 0x3f803f80
    v_mov_b32 v107, 0x3f803f80
    v_mov_b32 v109, 0
    v_mov_b32 v110, 0
    v_mov_b32 v111, 0
    v_cmp_gt_u32 s[76:77], 32, v0
    s_bfe_u32 s59, s51, 0x20001
    s_xor_b32 s59, s59, 0
    s_lshl_b32 s59, s59, 12
    s_add_u32 s59, s59, 32768
    v_add_u32 v119, s59, v116
L_xw:
    ds_read_b32 v3, v2 offset:2356
G_2:
    s_cbranch_execz G_4
    s_sub_u32 s68, s68, 1
    s_cbranch_scc1 L_cend
    s_waitcnt lgkmcnt(0)
    v_cmp_ne_u32 vcc, 0, v3
    s_cbranch_vccnz L_xw
    ds_read_b32 v3, v2 offset:2352
    ds_read_b128 v[128:131], v20 offset:0
    ds_read_b128 v[132:135], v21 offset:0
    ds_read_b128 v[136:139], v22 offset:0
    ds_read_b128 v[140:143], v23 offset:0
    ds_read_b128 v[144:147], v20 offset:256
    ds_read_b128 v[148:151], v21 offset:256
    ds_read_b128 v[152:155], v22 offset:256
    ds_read_b128 v[156:159], v23 offset:256
    ds_read_b128 v[160:163], v20 offset:512
    ds_read_b128 v[164:167], v21 offset:512
    ds_read_b128 v[168:171], v22 offset:512
    ds_read_b128 v[172:175], v23 offset:512
    ds_read_b128 v[176:179], v20 offset:768
    ds_read_b128 v[180:183], v21 offset:768
    ds_read_b128 v[184:187], v22 offset:768
    ds_read_b128 v[188:191], v23 offset:768
    s_waitcnt lgkmcnt(0)
    buffer_load_dword off, s[72:75], 0 offset:244 lds
    v_cmp_ne_u32 vcc, 0, v3
    s_cbranch_vccnz C_1
R_2:
    ds_read_b64_tr_b16 v[68:69], v8 offset:32768
    ds_read_b64_tr_b16 v[70:71], v8 offset:34816
    ds_read_b64_tr_b16 v[72:73], v9 offset:32768
    ds_read_b64_tr_b16 v[74:75], v9 offset:34816
    ds_read_b64_tr_b16 v[76:77], v10 offset:32768
    ds_read_b64_tr_b16 v[78:79], v10 offset:34816
    ds_read_b64_tr_b16 v[80:81], v11 offset:32768
    ds_read_b64_tr_b16 v[82:83], v11 offset:34816
    ds_read_b64_tr_b16 v[84:85], v12 offset:32768
    ds_read_b64_tr_b16 v[86:87], v12 offset:34816
G_18:
    s_cbranch_execz G_20
    ds_read_b64_tr_b16 v[88:89], v13 offset:32768
    ds_read_b64_tr_b16 v[90:91], v13 offset:34816
    ds_read_b32 v3, v2 offset:2348
    s_waitcnt lgkmcnt(9)
    v_mfma_f32_16x16x32_bf16 v[20:23], v[68:71], v[128:131], 0
    ds_read_b64_tr_b16 v[92:93], v14 offset:32768
    ds_read_b64_tr_b16 v[94:95], v14 offset:34816
    v_mfma_f32_16x16x32_bf16 v[24:27], v[72:75], v[128:131], 0
    ds_read_b64_tr_b16 v[96:97], v15 offset:32768
    ds_read_b64_tr_b16 v[98:99], v15 offset:34816
    s_waitcnt lgkmcnt(4)
    v_cmp_ne_u32 vcc, 0, v3
    v_mfma_f32_16x16x32_bf16 v[28:31], v[76:79], v[128:131], 0
    s_cbranch_vccnz C_3
R_4:
    ds_read_b64_tr_b16 v[68:69], v8 offset:49152
    ds_read_b64_tr_b16 v[70:71], v8 offset:51200
    v_mfma_f32_16x16x32_bf16 v[32:35], v[80:83], v[128:131], 0
    ds_read_b64_tr_b16 v[72:73], v9 offset:49152
    ds_read_b64_tr_b16 v[74:75], v9 offset:51200
    v_mfma_f32_16x16x32_bf16 v[36:39], v[84:87], v[128:131], 0
    ds_read_b64_tr_b16 v[76:77], v10 offset:49152
    ds_read_b64_tr_b16 v[78:79], v10 offset:51200
    v_mfma_f32_16x16x32_bf16 v[40:43], v[88:91], v[128:131], 0
    ds_read_b64_tr_b16 v[80:81], v11 offset:49152
    ds_read_b64_tr_b16 v[82:83], v11 offset:51200
    s_waitcnt lgkmcnt(8)
    v_mfma_f32_16x16x32_bf16 v[44:47], v[92:95], v[128:131], 0
    ds_read_b64_tr_b16 v[84:85], v12 offset:49152
    ds_read_b64_tr_b16 v[86:87], v12 offset:51200
    ds_read_b32 v3, v2 offset:2344
    v_mfma_f32_16x16x32_bf16 v[48:51], v[96:99], v[128:131], 0
    ds_read_b64_tr_b16 v[88:89], v13 offset:49152
    ds_read_b64_tr_b16 v[90:91], v13 offset:51200
    buffer_load_dword off, s[72:75], 0 offset:240 lds
G_19:
    s_cbranch_execz G_21
    s_waitcnt lgkmcnt(9)
    v_mfma_f32_16x16x32_bf16 v[20:23], v[68:71], v[132:135], v[20:23]
    ds_read_b64_tr_b16 v[92:93], v14 offset:49152
    ds_read_b64_tr_b16 v[94:95], v14 offset:51200
    v_mfma_f32_16x16x32_bf16 v[24:27], v[72:75], v[132:135], v[24:27]
    ds_read_b64_tr_b16 v[96:97], v15 offset:49152
    ds_read_b64_tr_b16 v[98:99], v15 offset:51200
    s_waitcnt lgkmcnt(6)
    v_cmp_ne_u32 vcc, 0, v3
    v_mfma_f32_16x16x32_bf16 v[28:31], v[76:79], v[132:135], v[28:31]
    s_cbranch_vccnz C_5
R_6:
    v_add_u32 v8, 65536, v8
    v_add_u32 v9, 65536, v9
    v_add_u32 v10, 65536, v10
    v_add_u32 v11, 65536, v11
    v_add_u32 v12, 65536, v12
    v_add_u32 v13, 65536, v13
    v_add_u32 v14, 65536, v14
    v_add_u32 v15, 65536, v15
    ds_read_b64_tr_b16 v[68:69], v8 offset:0
    ds_read_b64_tr_b16 v[70:71], v8 offset:2048
    v_mfma_f32_16x16x32_bf16 v[32:35], v[80:83], v[132:135], v[32:35]
    ds_read_b64_tr_b16 v[72:73], v9 offset:0
    ds_read_b64_tr_b16 v[74:75], v9 offset:2048
    s_waitcnt lgkmcnt(8)
    v_mfma_f32_16x16x32_bf16 v[36:39], v[84:87], v[132:135], v[36:39]
    ds_read_b64_tr_b16 v[76:77], v10 offset:0
    ds_read_b64_tr_b16 v[78:79], v10 offset:2048
    v_mfma_f32_16x16x32_bf16 v[40:43], v[88:91], v[132:135], v[40:43]
    ds_read_b64_tr_b16 v[80:81], v11 offset:0
    ds_read_b64_tr_b16 v[82:83], v11 offset:2048
    s_waitcnt lgkmcnt(8)
    v_mfma_f32_16x16x32_bf16 v[44:47], v[92:95], v[132:135], v[44:47]
    ds_read_b64_tr_b16 v[84:85], v12 offset:0
G_20:
    s_cbranch_execz G_22
    ds_read_b64_tr_b16 v[86:87], v12 offset:2048
    ds_read_b32 v3, v2 offset:2340
    v_mfma_f32_16x16x32_bf16 v[48:51], v[96:99], v[132:135], v[48:51]
    ds_read_b64_tr_b16 v[88:89], v13 offset:0
    ds_read_b64_tr_b16 v[90:91], v13 offset:2048
    buffer_load_dword off, s[72:75], 0 offset:236 lds
    s_waitcnt lgkmcnt(9)
    v_mfma_f32_16x16x32_bf16 v[20:23], v[68:71], v[136:139], v[20:23]
    ds_read_b64_tr_b16 v[92:93], v14 offset:0
    ds_read_b64_tr_b16 v[94:95], v14 offset:2048
    v_mfma_f32_16x16x32_bf16 v[24:27], v[72:75], v[136:139], v[24:27]
    ds_read_b64_tr_b16 v[96:97], v15 offset:0
    ds_read_b64_tr_b16 v[98:99], v15 offset:2048
    s_waitcnt lgkmcnt(6)
    v_cmp_ne_u32 vcc, 0, v3
    v_mfma_f32_16x16x32_bf16 v[28:31], v[76:79], v[136:139], v[28:31]
    s_cbranch_vccnz C_7
R_8:
    ds_read_b64_tr_b16 v[68:69], v8 offset:16384
    ds_read_b64_tr_b16 v[70:71], v8 offset:18432
    v_mfma_f32_16x16x32_bf16 v[32:35], v[80:83], v[136:139], v[32:35]
    ds_read_b64_tr_b16 v[72:73], v9 offset:16384
    ds_read_b64_tr_b16 v[74:75], v9 offset:18432
    s_waitcnt lgkmcnt(8)
    v_mfma_f32_16x16x32_bf16 v[36:39], v[84:87], v[136:139], v[36:39]
    ds_read_b64_tr_b16 v[76:77], v10 offset:16384
    ds_read_b64_tr_b16 v[78:79], v10 offset:18432
    v_mfma_f32_16x16x32_bf16 v[40:43], v[88:91], v[136:139], v[40:43]
    ds_read_b64_tr_b16 v[80:81], v11 offset:16384
    ds_read_b64_tr_b16 v[82:83], v11 offset:18432
    s_waitcnt lgkmcnt(8)
    v_mfma_f32_16x16x32_bf16 v[44:47], v[92:95], v[136:139], v[44:47]
    ds_read_b64_tr_b16 v[84:85], v12 offset:16384
    ds_read_b64_tr_b16 v[86:87], v12 offset:18432
    ds_read_b32 v3, v2 offset:2336
    v_mfma_f32_16x16x32_bf16 v[48:51], v[96:99], v[136:139], v[48:51]
G_21:
    s_cbranch_execz G_23
    ds_read_b64_tr_b16 v[88:89], v13 offset:16384
    ds_read_b64_tr_b16 v[90:91], v13 offset:18432
    buffer_load_dword off, s[72:75], 0 offset:232 lds
    s_waitcnt lgkmcnt(9)
    v_mfma_f32_16x16x32_bf16 v[20:23], v[68:71], v[140:143], v[20:23]
    ds_read_b64_tr_b16 v[92:93], v14 offset:16384
    ds_read_b64_tr_b16 v[94:95], v14 offset:18432
    v_mfma_f32_16x16x32_bf16 v[24:27], v[72:75], v[140:143], v[24:27]
    ds_read_b64_tr_b16 v[96:97], v15 offset:16384
    ds_read_b64_tr_b16 v[98:99], v15 offset:18432
    s_waitcnt lgkmcnt(6)
    v_cmp_ne_u32 vcc, 0, v3
    v_mfma_f32_16x16x32_bf16 v[28:31], v[76:79], v[140:143], v[28:31]
    s_cbranch_vccnz C_9
R_10:
    ds_read_b64_tr_b16 v[68:69], v8 offset:32768
    ds_read_b64_tr_b16 v[70:71], v8 offset:34816
    v_mfma_f32_16x16x32_bf16 v[32:35], v[80:83], v[140:143], v[32:35]
    ds_read_b64_tr_b16 v[72:73], v9 offset:32768
    ds_read_b64_tr_b16 v[74:75], v9 offset:34816
    s_waitcnt lgkmcnt(8)
    v_mfma_f32_16x16x32_bf16 v[36:39], v[84:87], v[140:143], v[36:39]
    ds_read_b64_tr_b16 v[76:77], v10 offset:32768
    ds_read_b64_tr_b16 v[78:79], v10 offset:34816
    v_mfma_f32_16x16x32_bf16 v[40:43], v[88:91], v[140:143], v[40:43]
    ds_read_b64_tr_b16 v[80:81], v11 offset:32768
    ds_read_b64_tr_b16 v[82:83], v11 offset:34816
    s_waitcnt lgkmcnt(8)
    v_mfma_f32_16x16x32_bf16 v[44:47], v[92:95], v[140:143], v[44:47]
    ds_read_b64_tr_b16 v[84:85], v12 offset:32768
    ds_read_b64_tr_b16 v[86:87], v12 offset:34816
    ds_read_b32 v3, v2 offset:2332
    v_mfma_f32_16x16x32_bf16 v[48:51], v[96:99], v[140:143], v[48:51]
    ds_read_b64_tr_b16 v[88:89], v13 offset:32768
    ds_read_b64_tr_b16 v[90:91], v13 offset:34816
G_22:
    s_cbranch_execz G_24
    buffer_load_dword off, s[72:75], 0 offset:228 lds
    s_waitcnt lgkmcnt(9)
    v_mfma_f32_16x16x32_bf16 v[20:23], v[68:71], v[144:147], v[20:23]
    ds_read_b64_tr_b16 v[92:93], v14 offset:32768
    ds_read_b64_tr_b16 v[94:95], v14 offset:34816
    v_mfma_f32_16x16x32_bf16 v[24:27], v[72:75], v[144:147], v[24:27]
    ds_read_b64_tr_b16 v[96:97], v15 offset:32768
    ds_read_b64_tr_b16 v[98:99], v15 offset:34816
    s_waitcnt lgkmcnt(6)
    v_cmp_ne_u32 vcc, 0, v3
    v_mfma_f32_16x16x32_bf16 v[28:31], v[76:79], v[144:147], v[28:31]
    s_cbranch_vccnz C_11
R_12:
    ds_read_b64_tr_b16 v[68:69], v8 offset:49152
    ds_read_b64_tr_b16 v[70:71], v8 offset:51200
    v_mfma_f32_16x16x32_bf16 v[32:35], v[80:83], v[144:147], v[32:35]
    ds_read_b64_tr_b16 v[72:73], v9 offset:49152
    ds_read_b64_tr_b16 v[74:75], v9 offset:51200
    s_waitcnt lgkmcnt(8)
    v_mfma_f32_16x16x32_bf16 v[36:39], v[84:87], v[144:147], v[36:39]
    ds_read_b64_tr_b16 v[76:77], v10 offset:49152
    ds_read_b64_tr_b16 v[78:79], v10 offset:51200
    v_mfma_f32_16x16x32_bf16 v[40:43], v[88:91], v[144:147], v[40:43]
    ds_read_b64_tr_b16 v[80:81], v11 offset:49152
    ds_read_b64_tr_b16 v[82:83], v11 offset:51200
    s_waitcnt lgkmcnt(8)
    v_mfma_f32_16x16x32_bf16 v[44:47], v[92:95], v[144:147], v[44:47]
    ds_read_b64_tr_b16 v[84:85], v12 offset:49152
    ds_read_b64_tr_b16 v[86:87], v12 offset:51200
    ds_read_b32 v3, v2 offset:2328
    v_mfma_f32_16x16x32_bf16 v[48:51], v[96:99], v[144:147], v[48:51]
    ds_read_b64_tr_b16 v[88:89], v13 offset:49152
    ds_read_b64_tr_b16 v[90:91], v13 offset:51200
    buffer_load_dword off, s[72:75], 0 offset:224 lds
    s_waitcnt lgkmcnt(9)
    v_mfma_f32_16x16x32_bf16 v[20:23], v[68:71], v[148:151], v[20:23]
G_23:
    s_cbranch_execz G_25
    ds_read_b64_tr_b16 v[92:93], v14 offset:49152
    ds_read_b64_tr_b16 v[94:95], v14 offset:51200
    s_bfe_u32 s59, s51, 0x20001
    s_xor_b32 s59, s59, 1
    v_mfma_f32_16x16x32_bf16 v[24:27], v[72:75], v[148:151], v[24:27]
    ds_read_b64_tr_b16 v[96:97], v15 offset:49152
    ds_read_b64_tr_b16 v[98:99], v15 offset:51200
    s_lshl_b32 s59, s59, 12
    s_waitcnt lgkmcnt(6)
    v_cmp_ne_u32 vcc, 0, v3
    v_mfma_f32_16x16x32_bf16 v[28:31], v[76:79], v[148:151], v[28:31]
    s_cbranch_vccnz C_13
R_14:
    v_add_u32 v8, 65536, v8
    v_add_u32 v9, 65536, v9
    v_add_u32 v10, 65536, v10
    v_add_u32 v11, 65536, v11
    v_add_u32 v12, 65536, v12
    v_add_u32 v13, 65536, v13
    v_add_u32 v14, 65536, v14
    v_add_u32 v15, 65536, v15
    ds_read_b64_tr_b16 v[68:69], v8 offset:0
    ds_read_b64_tr_b16 v[70:71], v8 offset:2048
    v_mfma_f32_16x16x32_bf16 v[32:35], v[80:83], v[148:151], v[32:35]
    ds_read_b64_tr_b16 v[72:73], v9 offset:0
    ds_read_b64_tr_b16 v[74:75], v9 offset:2048
    s_add_u32 s59, s59, 32768
    v_add_u32 v120, s59, v116
    s_waitcnt lgkmcnt(8)
    v_mfma_f32_16x16x32_bf16 v[36:39], v[84:87], v[148:151], v[36:39]
    ds_read_b64_tr_b16 v[76:77], v10 offset:0
    ds_read_b64_tr_b16 v[78:79], v10 offset:2048
    s_bfe_u32 s59, s51, 0x20001
    s_xor_b32 s59, s59, 2
    v_mfma_f32_16x16x32_bf16 v[40:43], v[88:91], v[148:151], v[40:43]
    ds_read_b64_tr_b16 v[80:81], v11 offset:0
    ds_read_b64_tr_b16 v[82:83], v11 offset:2048
G_24:
    s_cbranch_execz G_26
    s_lshl_b32 s59, s59, 12
    s_add_u32 s59, s59, 32768
    v_add_u32 v121, s59, v116
    s_waitcnt lgkmcnt(8)
    v_mfma_f32_16x16x32_bf16 v[44:47], v[92:95], v[148:151], v[44:47]
    ds_read_b64_tr_b16 v[84:85], v12 offset:0
    ds_read_b64_tr_b16 v[86:87], v12 offset:2048
    ds_read_b32 v3, v2 offset:2324
    v_mfma_f32_16x16x32_bf16 v[48:51], v[96:99], v[148:151], v[48:51]
    ds_read_b64_tr_b16 v[88:89], v13 offset:0
    ds_read_b64_tr_b16 v[90:91], v13 offset:2048
    buffer_load_dword off, s[72:75], 0 offset:220 lds
    s_waitcnt lgkmcnt(9)
    v_mfma_f32_16x16x32_bf16 v[20:23], v[68:71], v[152:155], v[20:23]
    ds_read_b64_tr_b16 v[92:93], v14 offset:0
    ds_read_b64_tr_b16 v[94:95], v14 offset:2048
    s_bfe_u32 s59, s51, 0x20001
    s_xor_b32 s59, s59, 3
    s_lshl_b32 s59, s59, 12
    v_mfma_f32_16x16x32_bf16 v[24:27], v[72:75], v[152:155], v[24:27]
    ds_read_b64_tr_b16 v[96:97], v15 offset:0
    ds_read_b64_tr_b16 v[98:99], v15 offset:2048
    s_waitcnt lgkmcnt(6)
    v_cmp_ne_u32 vcc, 0, v3
    v_mfma_f32_16x16x32_bf16 v[28:31], v[76:79], v[152:155], v[28:31]
    s_cbranch_vccnz C_15
R_16:
    v_subrev_u32 v8, 131072, v8
    v_subrev_u32 v9, 131072, v9
    v_subrev_u32 v10, 131072, v10
    v_subrev_u32 v11, 131072, v11
    v_subrev_u32 v12, 131072, v12
    v_subrev_u32 v13, 131072, v13
    v_subrev_u32 v14, 131072, v14
    v_subrev_u32 v15, 131072, v15
    ds_read_b64_tr_b16 v[68:69], v8 offset:0
    ds_read_b64_tr_b16 v[70:71], v8 offset:2048
G_25:
    s_cbranch_execz G_27
    v_mfma_f32_16x16x32_bf16 v[32:35], v[80:83], v[152:155], v[32:35]
    ds_read_b64_tr_b16 v[72:73], v9 offset:0
    ds_read_b64_tr_b16 v[74:75], v9 offset:2048
    s_add_u32 s59, s59, 32768
    v_add_u32 v122, s59, v116
    s_waitcnt lgkmcnt(8)
    v_mfma_f32_16x16x32_bf16 v[36:39], v[84:87], v[152:155], v[36:39]
    ds_read_b64_tr_b16 v[76:77], v10 offset:0
    ds_read_b64_tr_b16 v[78:79], v10 offset:2048
    s_lshr_b32 s92, s51, 3
    s_and_b32 s93, s51, 1
    s_lshl_b32 s93, s93, 1
    v_mfma_f32_16x16x32_bf16 v[40:43], v[88:91], v[152:155], v[40:43]
    ds_read_b64_tr_b16 v[80:81], v11 offset:0
    ds_read_b64_tr_b16 v[82:83], v11 offset:2048
    s_or_b32 s92, s92, s93
    s_xor_b32 s93, s92, 1
    s_waitcnt lgkmcnt(8)
    v_mfma_f32_16x16x32_bf16 v[44:47], v[92:95], v[152:155], v[44:47]
    ds_read_b64_tr_b16 v[84:85], v12 offset:0
    ds_read_b64_tr_b16 v[86:87], v12 offset:2048
    ds_read_b32 v3, v2 offset:2320
    s_lshl_b32 s61, s51, 8
    v_mfma_f32_16x16x32_bf16 v[48:51], v[96:99], v[152:155], v[48:51]
    ds_read_b64_tr_b16 v[88:89], v13 offset:0
    ds_read_b64_tr_b16 v[90:91], v13 offset:2048
    buffer_load_dword off, s[72:75], 0 offset:216 lds
    s_waitcnt lgkmcnt(9)
    v_mfma_f32_16x16x32_bf16 v[20:23], v[68:71], v[156:159], v[20:23]
    ds_read_b64_tr_b16 v[92:93], v14 offset:0
    ds_read_b64_tr_b16 v[94:95], v14 offset:2048
    s_lshl_b32 s59, s49, 4
    s_add_u32 s61, s61, s59
    v_mfma_f32_16x16x32_bf16 v[24:27], v[72:75], v[156:159], v[24:27]
    ds_read_b64_tr_b16 v[96:97], v15 offset:0
    ds_read_b64_tr_b16 v[98:99], v15 offset:2048
    s_waitcnt lgkmcnt(6)
    v_cmp_ne_u32 vcc, 0, v3
G_26:
    s_cbranch_execz G_28
    v_mfma_f32_16x16x32_bf16 v[28:31], v[76:79], v[156:159], v[28:31]
    s_cbranch_vccnz C_17
R_18:
    ds_read_b64_tr_b16 v[68:69], v8 offset:16384
    ds_read_b64_tr_b16 v[70:71], v8 offset:18432
    v_mfma_f32_16x16x32_bf16 v[32:35], v[80:83], v[156:159], v[32:35]
    ds_read_b64_tr_b16 v[72:73], v9 offset:16384
    ds_read_b64_tr_b16 v[74:75], v9 offset:18432
    s_add_u32 s61, s61, s53
    s_mul_i32 s61, s61, 2048
    s_mul_i32 s59, s92, 131072
    s_waitcnt lgkmcnt(8)
    v_mfma_f32_16x16x32_bf16 v[36:39], v[84:87], v[156:159], v[36:39]
    ds_read_b64_tr_b16 v[76:77], v10 offset:16384
    ds_read_b64_tr_b16 v[78:79], v10 offset:18432
    s_add_u32 s20, s59, s61
    s_xor_b32 s22, s20, 524288
    v_mfma_f32_16x16x32_bf16 v[40:43], v[88:91], v[156:159], v[40:43]
    ds_read_b64_tr_b16 v[80:81], v11 offset:16384
    ds_read_b64_tr_b16 v[82:83], v11 offset:18432
    s_mul_i32 s59, s93, 131072
    s_add_u32 s21, s59, s61
    s_waitcnt lgkmcnt(8)
    v_mfma_f32_16x16x32_bf16 v[44:47], v[92:95], v[156:159], v[44:47]
    ds_read_b64_tr_b16 v[84:85], v12 offset:16384
    ds_read_b64_tr_b16 v[86:87], v12 offset:18432
    ds_read_b32 v3, v2 offset:2316
    s_xor_b32 s23, s21, 524288
    v_mfma_f32_16x16x32_bf16 v[48:51], v[96:99], v[156:159], v[48:51]
    ds_read_b64_tr_b16 v[88:89], v13 offset:16384
    ds_read_b64_tr_b16 v[90:91], v13 offset:18432
    buffer_load_dword off, s[72:75], 0 offset:212 lds
    s_waitcnt lgkmcnt(9)
    v_mfma_f32_16x16x32_bf16 v[20:23], v[68:71], v[160:163], v[20:23]
    ds_read_b64_tr_b16 v[92:93], v14 offset:16384
    ds_read_b64_tr_b16 v[94:95], v14 offset:18432
G_27:
    s_cbranch_execz G_29
    s_lshl_b32 s59, s51, 4
    s_add_u32 s59, s59, s53
    v_mfma_f32_16x16x32_bf16 v[24:27], v[72:75], v[160:163], v[24:27]
    ds_read_b64_tr_b16 v[96:97], v15 offset:16384
    ds_read_b64_tr_b16 v[98:99], v15 offset:18432
    s_waitcnt lgkmcnt(6)
    v_cmp_ne_u32 vcc, 0, v3
    v_mfma_f32_16x16x32_bf16 v[28:31], v[76:79], v[160:163], v[28:31]
    s_cbranch_vccnz C_19
R_20:
    ds_read_b64_tr_b16 v[68:69], v8 offset:32768
    ds_read_b64_tr_b16 v[70:71], v8 offset:34816
    s_lshl_b32 s26, s59, 14
    v_mfma_f32_16x16x32_bf16 v[32:35], v[80:83], v[160:163], v[32:35]
    ds_read_b64_tr_b16 v[72:73], v9 offset:32768
    ds_read_b64_tr_b16 v[74:75], v9 offset:34816
    s_add_u32 s26, s26, 25133056
    s_add_u32 s27, s26, 4096
    s_waitcnt lgkmcnt(8)
    v_mfma_f32_16x16x32_bf16 v[36:39], v[84:87], v[160:163], v[36:39]
    ds_read_b64_tr_b16 v[76:77], v10 offset:32768
    ds_read_b64_tr_b16 v[78:79], v10 offset:34816
    s_lshl_b32 s28, s59, 7
    s_lshl_b32 s59, s49, 2
    v_mfma_f32_16x16x32_bf16 v[40:43], v[88:91], v[160:163], v[40:43]
    ds_read_b64_tr_b16 v[80:81], v11 offset:32768
    ds_read_b64_tr_b16 v[82:83], v11 offset:34816
    s_add_u32 s28, s28, s59
    s_add_u32 s28, s28, 35651584
    s_waitcnt lgkmcnt(8)
    v_mfma_f32_16x16x32_bf16 v[44:47], v[92:95], v[160:163], v[44:47]
    ds_read_b64_tr_b16 v[84:85], v12 offset:32768
    ds_read_b64_tr_b16 v[86:87], v12 offset:34816
    ds_read_b32 v3, v2 offset:2312
    v_and_b32 v5, 31, v0
    v_mfma_f32_16x16x32_bf16 v[48:51], v[96:99], v[160:163], v[48:51]
    ds_read_b64_tr_b16 v[88:89], v13 offset:32768
    ds_read_b64_tr_b16 v[90:91], v13 offset:34816
    buffer_load_dword off, s[72:75], 0 offset:208 lds
G_28:
    s_cbranch_execz G_30
    s_waitcnt lgkmcnt(9)
    v_mfma_f32_16x16x32_bf16 v[20:23], v[68:71], v[164:167], v[20:23]
    ds_read_b64_tr_b16 v[92:93], v14 offset:32768
    ds_read_b64_tr_b16 v[94:95], v14 offset:34816
    v_lshlrev_b32 v6, 4, v5
    v_lshl_add_u32 v125, v7, 11, v6
    v_mfma_f32_16x16x32_bf16 v[24:27], v[72:75], v[164:167], v[24:27]
    ds_read_b64_tr_b16 v[96:97], v15 offset:32768
    ds_read_b64_tr_b16 v[98:99], v15 offset:34816
    v_and_b32 v124, 1, v0
    s_waitcnt lgkmcnt(6)
    v_cmp_ne_u32 vcc, 0, v3
    v_mfma_f32_16x16x32_bf16 v[28:31], v[76:79], v[164:167], v[28:31]
    s_cbranch_vccnz C_21
R_22:
    ds_read_b64_tr_b16 v[68:69], v8 offset:49152
    ds_read_b64_tr_b16 v[70:71], v8 offset:51200
    v_mfma_f32_16x16x32_bf16 v[32:35], v[80:83], v[164:167], v[32:35]
    ds_read_b64_tr_b16 v[72:73], v9 offset:49152
    ds_read_b64_tr_b16 v[74:75], v9 offset:51200
    v_lshlrev_b32 v124, 13, v124
    v_lshl_add_u32 v124, v17, 15, v124
    s_waitcnt lgkmcnt(8)
    v_mfma_f32_16x16x32_bf16 v[36:39], v[84:87], v[164:167], v[36:39]
    ds_read_b64_tr_b16 v[76:77], v10 offset:49152
    ds_read_b64_tr_b16 v[78:79], v10 offset:51200
    v_lshlrev_b32 v5, 10, v5
    v_lshl_add_u32 v126, v7, 3, v5
    v_mfma_f32_16x16x32_bf16 v[40:43], v[88:91], v[164:167], v[40:43]
    ds_read_b64_tr_b16 v[80:81], v11 offset:49152
    ds_read_b64_tr_b16 v[82:83], v11 offset:51200
    s_and_b32 s24, s51, 14
    s_lshl_b32 s24, s24, 15
    s_add_u32 s24, s24, 33554432
    s_waitcnt lgkmcnt(8)
    v_mfma_f32_16x16x32_bf16 v[44:47], v[92:95], v[164:167], v[44:47]
    ds_read_b64_tr_b16 v[84:85], v12 offset:49152
    ds_read_b64_tr_b16 v[86:87], v12 offset:51200
G_29:
    s_cbranch_execz G_31
    ds_read_b32 v3, v2 offset:2308
    v_mfma_f32_16x16x32_bf16 v[48:51], v[96:99], v[164:167], v[48:51]
    ds_read_b64_tr_b16 v[88:89], v13 offset:49152
    ds_read_b64_tr_b16 v[90:91], v13 offset:51200
    buffer_load_dword off, s[72:75], 0 offset:204 lds
    s_waitcnt lgkmcnt(9)
    v_mfma_f32_16x16x32_bf16 v[20:23], v[68:71], v[168:171], v[20:23]
    ds_read_b64_tr_b16 v[92:93], v14 offset:49152
    ds_read_b64_tr_b16 v[94:95], v14 offset:51200
    s_lshl_b32 s59, s49, 11
    s_add_u32 s24, s24, s59
    s_and_b32 s59, s51, 1
    v_mfma_f32_16x16x32_bf16 v[24:27], v[72:75], v[168:171], v[24:27]
    ds_read_b64_tr_b16 v[96:97], v15 offset:49152
    ds_read_b64_tr_b16 v[98:99], v15 offset:51200
    s_waitcnt lgkmcnt(6)
    v_cmp_ne_u32 vcc, 0, v3
    v_mfma_f32_16x16x32_bf16 v[28:31], v[76:79], v[168:171], v[28:31]
    s_cbranch_vccnz C_23
R_24:
    v_add_u32 v8, 65536, v8
    v_add_u32 v9, 65536, v9
    v_add_u32 v10, 65536, v10
    v_add_u32 v11, 65536, v11
    v_add_u32 v12, 65536, v12
    v_add_u32 v13, 65536, v13
    v_add_u32 v14, 65536, v14
    v_add_u32 v15, 65536, v15
    ds_read_b64_tr_b16 v[68:69], v8 offset:0
    ds_read_b64_tr_b16 v[70:71], v8 offset:2048
    v_mfma_f32_16x16x32_bf16 v[32:35], v[80:83], v[168:171], v[32:35]
    ds_read_b64_tr_b16 v[72:73], v9 offset:0
    ds_read_b64_tr_b16 v[74:75], v9 offset:2048
    s_lshl_b32 s59, s59, 14
    s_add_u32 s24, s24, s59
    s_waitcnt lgkmcnt(8)
    v_mfma_f32_16x16x32_bf16 v[36:39], v[84:87], v[168:171], v[36:39]
    ds_read_b64_tr_b16 v[76:77], v10 offset:0
G_30:
    s_cbranch_execz G_32
    ds_read_b64_tr_b16 v[78:79], v10 offset:2048
    s_lshl_b32 s59, s53, 2
    s_add_u32 s24, s24, s59
    s_lshl_b32 s60, s51, 4
    v_mfma_f32_16x16x32_bf16 v[40:43], v[88:91], v[168:171], v[40:43]
    ds_read_b64_tr_b16 v[80:81], v11 offset:0
    ds_read_b64_tr_b16 v[82:83], v11 offset:2048
    s_add_u32 s60, s60, s53
    s_mul_i32 s60, s60, 32768
    s_waitcnt lgkmcnt(8)
    v_mfma_f32_16x16x32_bf16 v[44:47], v[92:95], v[168:171], v[44:47]
    ds_read_b64_tr_b16 v[84:85], v12 offset:0
    ds_read_b64_tr_b16 v[86:87], v12 offset:2048
    ds_read_b32 v3, v2 offset:2304
    s_lshl_b32 s59, s49, 9
    v_mfma_f32_16x16x32_bf16 v[48:51], v[96:99], v[168:171], v[48:51]
    ds_read_b64_tr_b16 v[88:89], v13 offset:0
    ds_read_b64_tr_b16 v[90:91], v13 offset:2048
    buffer_load_dword off, s[72:75], 0 offset:200 lds
    s_waitcnt lgkmcnt(9)
    v_mfma_f32_16x16x32_bf16 v[20:23], v[68:71], v[172:175], v[20:23]
    ds_read_b64_tr_b16 v[92:93], v14 offset:0
    ds_read_b64_tr_b16 v[94:95], v14 offset:2048
    s_add_u32 s80, s60, s59
    s_add_u32 s81, s80, 4096
    v_mfma_f32_16x16x32_bf16 v[24:27], v[72:75], v[172:175], v[24:27]
    ds_read_b64_tr_b16 v[96:97], v15 offset:0
    ds_read_b64_tr_b16 v[98:99], v15 offset:2048
    s_waitcnt lgkmcnt(6)
    v_cmp_ne_u32 vcc, 0, v3
    v_mfma_f32_16x16x32_bf16 v[28:31], v[76:79], v[172:175], v[28:31]
    s_cbranch_vccnz C_25
R_26:
    ds_read_b64_tr_b16 v[68:69], v8 offset:16384
    ds_read_b64_tr_b16 v[70:71], v8 offset:18432
    v_mfma_f32_16x16x32_bf16 v[32:35], v[80:83], v[172:175], v[32:35]
    ds_read_b64_tr_b16 v[72:73], v9 offset:16384
    ds_read_b64_tr_b16 v[74:75], v9 offset:18432
G_31:
    s_cbranch_execz G_33
    s_add_u32 s82, s80, 8192
    s_add_u32 s83, s80, 12288
    s_add_u32 s84, s80, 16384
    s_waitcnt lgkmcnt(8)
    v_mfma_f32_16x16x32_bf16 v[36:39], v[84:87], v[172:175], v[36:39]
    ds_read_b64_tr_b16 v[76:77], v10 offset:16384
    ds_read_b64_tr_b16 v[78:79], v10 offset:18432
    s_add_u32 s85, s80, 20480
    s_add_u32 s86, s80, 24576
    v_mfma_f32_16x16x32_bf16 v[40:43], v[88:91], v[172:175], v[40:43]
    ds_read_b64_tr_b16 v[80:81], v11 offset:16384
    ds_read_b64_tr_b16 v[82:83], v11 offset:18432
    s_add_u32 s87, s80, 28672
    s_lshl_b32 s33, s51, 15
    s_waitcnt lgkmcnt(8)
    v_mfma_f32_16x16x32_bf16 v[44:47], v[92:95], v[172:175], v[44:47]
    ds_read_b64_tr_b16 v[84:85], v12 offset:16384
    ds_read_b64_tr_b16 v[86:87], v12 offset:18432
    ds_read_b32 v3, v2 offset:2300
    s_lshl_b32 s59, s53, 6
    v_mfma_f32_16x16x32_bf16 v[48:51], v[96:99], v[172:175], v[48:51]
    ds_read_b64_tr_b16 v[88:89], v13 offset:16384
    ds_read_b64_tr_b16 v[90:91], v13 offset:18432
    buffer_load_dword off, s[72:75], 0 offset:196 lds
    s_waitcnt lgkmcnt(9)
    v_mfma_f32_16x16x32_bf16 v[20:23], v[68:71], v[176:179], v[20:23]
    ds_read_b64_tr_b16 v[92:93], v14 offset:16384
    ds_read_b64_tr_b16 v[94:95], v14 offset:18432
    s_add_u32 s33, s33, s59
    s_lshl_b32 s59, s56, 5
    v_mfma_f32_16x16x32_bf16 v[24:27], v[72:75], v[176:179], v[24:27]
    ds_read_b64_tr_b16 v[96:97], v15 offset:16384
    ds_read_b64_tr_b16 v[98:99], v15 offset:18432
    s_waitcnt lgkmcnt(6)
    v_cmp_ne_u32 vcc, 0, v3
    v_mfma_f32_16x16x32_bf16 v[28:31], v[76:79], v[176:179], v[28:31]
G_32:
    s_cbranch_execz G_34
    s_cbranch_vccnz C_27
R_28:
    ds_read_b64_tr_b16 v[68:69], v8 offset:32768
    ds_read_b64_tr_b16 v[70:71], v8 offset:34816
    s_add_u32 s33, s33, s59
    v_mfma_f32_16x16x32_bf16 v[32:35], v[80:83], v[176:179], v[32:35]
    ds_read_b64_tr_b16 v[72:73], v9 offset:32768
    ds_read_b64_tr_b16 v[74:75], v9 offset:34816
    s_lshl_b32 s59, s57, 4
    s_add_u32 s33, s33, s59
    s_waitcnt lgkmcnt(8)
    v_mfma_f32_16x16x32_bf16 v[36:39], v[84:87], v[176:179], v[36:39]
    ds_read_b64_tr_b16 v[76:77], v10 offset:32768
    ds_read_b64_tr_b16 v[78:79], v10 offset:34816
    s_mov_b32 s44, s14
    s_mov_b32 s45, s15
    v_mfma_f32_16x16x32_bf16 v[40:43], v[88:91], v[176:179], v[40:43]
    ds_read_b64_tr_b16 v[80:81], v11 offset:32768
    ds_read_b64_tr_b16 v[82:83], v11 offset:34816
    s_mov_b32 s46, 524288
    s_mov_b32 s47, 0x20000
    s_waitcnt lgkmcnt(8)
    v_mfma_f32_16x16x32_bf16 v[44:47], v[92:95], v[176:179], v[44:47]
    ds_read_b64_tr_b16 v[84:85], v12 offset:32768
    ds_read_b64_tr_b16 v[86:87], v12 offset:34816
    ds_read_b32 v3, v2 offset:2296
    v_mfma_f32_16x16x32_bf16 v[48:51], v[96:99], v[176:179], v[48:51]
    ds_read_b64_tr_b16 v[88:89], v13 offset:32768
    ds_read_b64_tr_b16 v[90:91], v13 offset:34816
    buffer_load_dword off, s[72:75], 0 offset:192 lds
    s_waitcnt lgkmcnt(9)
    v_mfma_f32_16x16x32_bf16 v[20:23], v[68:71], v[180:183], v[20:23]
    ds_read_b64_tr_b16 v[92:93], v14 offset:32768
    ds_read_b64_tr_b16 v[94:95], v14 offset:34816
    v_mfma_f32_16x16x32_bf16 v[24:27], v[72:75], v[180:183], v[24:27]
    ds_read_b64_tr_b16 v[96:97], v15 offset:32768
    ds_read_b64_tr_b16 v[98:99], v15 offset:34816
G_33:
    s_cbranch_execz G_35
    s_waitcnt lgkmcnt(6)
    v_cmp_ne_u32 vcc, 0, v3
    v_mfma_f32_16x16x32_bf16 v[28:31], v[76:79], v[180:183], v[28:31]
    s_cbranch_vccnz C_29
R_30:
    ds_read_b64_tr_b16 v[68:69], v8 offset:49152
    ds_read_b64_tr_b16 v[70:71], v8 offset:51200
    v_mfma_f32_16x16x32_bf16 v[32:35], v[80:83], v[180:183], v[32:35]
    ds_read_b64_tr_b16 v[72:73], v9 offset:49152
    ds_read_b64_tr_b16 v[74:75], v9 offset:51200
    s_waitcnt lgkmcnt(8)
    v_mfma_f32_16x16x32_bf16 v[36:39], v[84:87], v[180:183], v[36:39]
    ds_read_b64_tr_b16 v[76:77], v10 offset:49152
    ds_read_b64_tr_b16 v[78:79], v10 offset:51200
    v_mfma_f32_16x16x32_bf16 v[40:43], v[88:91], v[180:183], v[40:43]
    ds_read_b64_tr_b16 v[80:81], v11 offset:49152
    ds_read_b64_tr_b16 v[82:83], v11 offset:51200
    s_waitcnt lgkmcnt(8)
    v_mfma_f32_16x16x32_bf16 v[44:47], v[92:95], v[180:183], v[44:47]
    ds_read_b64_tr_b16 v[84:85], v12 offset:49152
    ds_read_b64_tr_b16 v[86:87], v12 offset:51200
    ds_read_b32 v3, v2 offset:2292
    v_mfma_f32_16x16x32_bf16 v[48:51], v[96:99], v[180:183], v[48:51]
    ds_read_b64_tr_b16 v[88:89], v13 offset:49152
    ds_read_b64_tr_b16 v[90:91], v13 offset:51200
    buffer_load_dword off, s[72:75], 0 offset:188 lds
    s_waitcnt lgkmcnt(9)
    v_mfma_f32_16x16x32_bf16 v[20:23], v[68:71], v[184:187], v[20:23]
    ds_read_b64_tr_b16 v[92:93], v14 offset:49152
    ds_read_b64_tr_b16 v[94:95], v14 offset:51200
    v_mfma_f32_16x16x32_bf16 v[24:27], v[72:75], v[184:187], v[24:27]
    ds_read_b64_tr_b16 v[96:97], v15 offset:49152
    ds_read_b64_tr_b16 v[98:99], v15 offset:51200
    s_waitcnt lgkmcnt(6)
    v_cmp_ne_u32 vcc, 0, v3
    v_mfma_f32_16x16x32_bf16 v[28:31], v[76:79], v[184:187], v[28:31]
G_34:
    s_cbranch_execz G_36
    s_cbranch_vccnz C_31
R_32:
    v_add_u32 v8, 65536, v8
    v_add_u32 v9, 65536, v9
    v_add_u32 v10, 65536, v10
    v_add_u32 v11, 65536, v11
    v_add_u32 v12, 65536, v12
    v_add_u32 v13, 65536, v13
    v_add_u32 v14, 65536, v14
    v_add_u32 v15, 65536, v15
    ds_read_b64_tr_b16 v[68:69], v8 offset:0
    ds_read_b64_tr_b16 v[70:71], v8 offset:2048
    v_mfma_f32_16x16x32_bf16 v[32:35], v[80:83], v[184:187], v[32:35]
    ds_read_b64_tr_b16 v[72:73], v9 offset:0
    ds_read_b64_tr_b16 v[74:75], v9 offset:2048
    s_waitcnt lgkmcnt(8)
    v_mfma_f32_16x16x32_bf16 v[36:39], v[84:87], v[184:187], v[36:39]
    ds_read_b64_tr_b16 v[76:77], v10 offset:0
    ds_read_b64_tr_b16 v[78:79], v10 offset:2048
    v_mfma_f32_16x16x32_bf16 v[40:43], v[88:91], v[184:187], v[40:43]
    ds_read_b64_tr_b16 v[80:81], v11 offset:0
    ds_read_b64_tr_b16 v[82:83], v11 offset:2048
    s_waitcnt lgkmcnt(8)
    v_mfma_f32_16x16x32_bf16 v[44:47], v[92:95], v[184:187], v[44:47]
    ds_read_b64_tr_b16 v[84:85], v12 offset:0
    ds_read_b64_tr_b16 v[86:87], v12 offset:2048
    v_mfma_f32_16x16x32_bf16 v[48:51], v[96:99], v[184:187], v[48:51]
    ds_read_b64_tr_b16 v[88:89], v13 offset:0
    ds_read_b64_tr_b16 v[90:91], v13 offset:2048
    buffer_load_dword off, s[72:75], 0 offset:184 lds
    s_waitcnt lgkmcnt(8)
    v_mfma_f32_16x16x32_bf16 v[20:23], v[68:71], v[188:191], v[20:23]
    ds_read_b64_tr_b16 v[92:93], v14 offset:0
    ds_read_b64_tr_b16 v[94:95], v14 offset:2048
    v_mfma_f32_16x16x32_bf16 v[24:27], v[72:75], v[188:191], v[24:27]
G_35:
    s_cbranch_execz G_37
    ds_read_b64_tr_b16 v[96:97], v15 offset:0
    ds_read_b64_tr_b16 v[98:99], v15 offset:2048
    s_waitcnt lgkmcnt(8)
    v_mfma_f32_16x16x32_bf16 v[28:31], v[76:79], v[188:191], v[28:31]
    v_mfma_f32_16x16x32_bf16 v[32:35], v[80:83], v[188:191], v[32:35]
    s_waitcnt lgkmcnt(4)
    v_mfma_f32_16x16x32_bf16 v[36:39], v[84:87], v[188:191], v[36:39]
    v_mov_b32 v8, v113
    v_xor_b32 v9, 64, v113
    v_xor_b32 v10, 128, v113
    v_xor_b32 v11, 192, v113
    v_mfma_f32_16x16x32_bf16 v[40:43], v[88:91], v[188:191], v[40:43]
    s_waitcnt vmcnt(16)
    s_mov_b32 s59, 0x41C64E6D
    v_mul_lo_u32 v118, v118, s59
    v_add_u32 v118, 0x7F4A7C15, v118
    s_waitcnt lgkmcnt(0)
    v_mfma_f32_16x16x32_bf16 v[44:47], v[92:95], v[188:191], v[44:47]
    ds_read_b32 v3, v2 offset:2288
    v_mfma_f32_16x16x32_bf16 v[48:51], v[96:99], v[188:191], v[48:51]
    buffer_load_dword off, s[72:75], 0 offset:180 lds
    ds_write_b32 v1, v118 offset:4480
    v_mul_f32 v20, s58, v20
    v_mul_f32 v21, s58, v21
    v_mul_f32 v22, s58, v22
    v_mul_f32 v23, s58, v23
    v_mul_f32 v24, s58, v24
    v_mul_f32 v25, s58, v25
    v_mul_f32 v26, s58, v26
    v_mul_f32 v27, s58, v27
    v_cvt_pk_bf16_f32 v52, v20, v21
    v_cvt_pk_bf16_f32 v53, v22, v23
    v_cvt_pk_bf16_f32 v54, v24, v25
    v_cvt_pk_bf16_f32 v55, v26, v27
    v_mul_f32 v28, s58, v28
    v_mul_f32 v29, s58, v29
    v_mul_f32 v30, s58, v30
    v_mul_f32 v31, s58, v31
    v_mul_f32 v32, s58, v32
    v_mul_f32 v33, s58, v33
    v_mul_f32 v34, s58, v34
    v_mul_f32 v35, s58, v35
G_36:
    s_cbranch_execz G_38
    v_cvt_pk_bf16_f32 v56, v28, v29
    v_cvt_pk_bf16_f32 v57, v30, v31
    v_cvt_pk_bf16_f32 v58, v32, v33
    v_cvt_pk_bf16_f32 v59, v34, v35
    v_permlane16_swap_b32 v52, v54
    v_permlane16_swap_b32 v53, v55
    v_mul_f32 v36, s58, v36
    v_mul_f32 v37, s58, v37
    v_mul_f32 v38, s58, v38
    v_mul_f32 v39, s58, v39
    v_mul_f32 v40, s58, v40
    v_mul_f32 v41, s58, v41
    v_mul_f32 v42, s58, v42
    v_mul_f32 v43, s58, v43
    v_cvt_pk_bf16_f32 v60, v36, v37
    v_cvt_pk_bf16_f32 v61, v38, v39
    v_cvt_pk_bf16_f32 v62, v40, v41
    v_cvt_pk_bf16_f32 v63, v42, v43
    v_permlane16_swap_b32 v56, v58
    v_permlane16_swap_b32 v57, v59
    v_mul_f32 v44, s58, v44
    v_mul_f32 v45, s58, v45
    v_mul_f32 v46, s58, v46
    v_mul_f32 v47, s58, v47
    v_mul_f32 v48, s58, v48
    v_mul_f32 v49, s58, v49
    v_mul_f32 v50, s58, v50
    v_mul_f32 v51, s58, v51
    v_cvt_pk_bf16_f32 v64, v44, v45
    v_cvt_pk_bf16_f32 v65, v46, v47
    v_cvt_pk_bf16_f32 v66, v48, v49
    v_cvt_pk_bf16_f32 v67, v50, v51
    v_permlane16_swap_b32 v60, v62
    v_permlane16_swap_b32 v61, v63
    v_permlane16_swap_b32 v64, v66
    v_permlane16_swap_b32 v65, v67
L_kv:
    s_waitcnt lgkmcnt(1)
    v_cmp_ne_u32 vcc, 0, v3
    s_cbranch_vccnz C_33
R_34:
    ds_read_b128 v[68:71], v8 offset:0
    ds_read_b128 v[72:75], v8 offset:4096
    ds_read_b128 v[76:79], v8 offset:8192
    ds_read_b128 v[80:83], v8 offset:12288
    ds_read_b128 v[84:87], v9 offset:0
    ds_read_b128 v[88:91], v9 offset:4096
G_37:
    s_cbranch_execz G_39
    s_waitcnt lgkmcnt(4)
    v_mfma_f32_16x16x32_bf16 v[128:131], v[68:71], v[52:55], 0
    ds_read_b128 v[92:95], v9 offset:8192
    v_mfma_f32_16x16x32_bf16 v[132:135], v[72:75], v[52:55], 0
    ds_read_b128 v[96:99], v9 offset:12288
    s_waitcnt lgkmcnt(4)
    v_mfma_f32_16x16x32_bf16 v[136:139], v[76:79], v[52:55], 0
    ds_read_b128 v[20:23], v10 offset:0
    v_mfma_f32_16x16x32_bf16 v[140:143], v[80:83], v[52:55], 0
    ds_read_b128 v[24:27], v10 offset:4096
    s_waitcnt lgkmcnt(4)
    v_mfma_f32_16x16x32_bf16 v[128:131], v[84:87], v[56:59], v[128:131]
    ds_read_b128 v[28:31], v10 offset:8192
    v_mfma_f32_16x16x32_bf16 v[132:135], v[88:91], v[56:59], v[132:135]
    ds_read_b128 v[32:35], v10 offset:12288
    s_waitcnt lgkmcnt(4)
    v_mfma_f32_16x16x32_bf16 v[136:139], v[92:95], v[56:59], v[136:139]
    ds_read_b128 v[36:39], v11 offset:0
    ds_read_b32 v3, v2 offset:2284
    v_mfma_f32_16x16x32_bf16 v[140:143], v[96:99], v[56:59], v[140:143]
    ds_read_b128 v[40:43], v11 offset:4096
    s_waitcnt lgkmcnt(5)
    v_mfma_f32_16x16x32_bf16 v[128:131], v[20:23], v[60:63], v[128:131]
    ds_read_b128 v[44:47], v11 offset:8192
    v_mfma_f32_16x16x32_bf16 v[132:135], v[24:27], v[60:63], v[132:135]
    ds_read_b128 v[48:51], v11 offset:12288
    s_waitcnt lgkmcnt(3)
    v_cmp_ne_u32 vcc, 0, v3
    v_mfma_f32_16x16x32_bf16 v[136:139], v[28:31], v[60:63], v[136:139]
    s_cbranch_vccnz C_35
R_36:
    ds_read_b128 v[68:71], v8 offset:16384
    v_mfma_f32_16x16x32_bf16 v[140:143], v[32:35], v[60:63], v[140:143]
    ds_read_b128 v[72:75], v8 offset:20480
    s_waitcnt lgkmcnt(4)
    v_mfma_f32_16x16x32_bf16 v[128:131], v[36:39], v[64:67], v[128:131]
    ds_read_b128 v[76:79], v8 offset:24576
G_38:
    s_cbranch_execz G_40
    v_mfma_f32_16x16x32_bf16 v[132:135], v[40:43], v[64:67], v[132:135]
    ds_read_b128 v[80:83], v8 offset:28672
    s_waitcnt lgkmcnt(4)
    v_mfma_f32_16x16x32_bf16 v[136:139], v[44:47], v[64:67], v[136:139]
    ds_read_b128 v[84:87], v9 offset:16384
    v_mfma_f32_16x16x32_bf16 v[140:143], v[48:51], v[64:67], v[140:143]
    ds_read_b128 v[88:91], v9 offset:20480
    buffer_load_dword off, s[72:75], 0 offset:176 lds
    s_waitcnt lgkmcnt(4)
    v_mfma_f32_16x16x32_bf16 v[144:147], v[68:71], v[52:55], 0
    ds_read_b128 v[92:95], v9 offset:24576
    v_mfma_f32_16x16x32_bf16 v[148:151], v[72:75], v[52:55], 0
    ds_read_b128 v[96:99], v9 offset:28672
    s_waitcnt lgkmcnt(4)
    v_mfma_f32_16x16x32_bf16 v[152:155], v[76:79], v[52:55], 0
    ds_read_b128 v[20:23], v10 offset:16384
    v_mfma_f32_16x16x32_bf16 v[156:159], v[80:83], v[52:55], 0
    ds_read_b128 v[24:27], v10 offset:20480
    v_max_f32 v7, v128, v129
    s_waitcnt lgkmcnt(4)
    v_mfma_f32_16x16x32_bf16 v[144:147], v[84:87], v[56:59], v[144:147]
    ds_read_b128 v[28:31], v10 offset:24576
    v_max3_f32 v7, v7, v130, v131
    v_mfma_f32_16x16x32_bf16 v[148:151], v[88:91], v[56:59], v[148:151]
    ds_read_b128 v[32:35], v10 offset:28672
    v_max3_f32 v7, v7, v132, v133
    s_waitcnt lgkmcnt(4)
    v_mfma_f32_16x16x32_bf16 v[152:155], v[92:95], v[56:59], v[152:155]
    ds_read_b128 v[36:39], v11 offset:16384
    ds_read_b32 v3, v2 offset:2280
    v_mfma_f32_16x16x32_bf16 v[156:159], v[96:99], v[56:59], v[156:159]
    ds_read_b128 v[40:43], v11 offset:20480
    v_max3_f32 v7, v7, v134, v135
    s_waitcnt lgkmcnt(5)
    v_mfma_f32_16x16x32_bf16 v[144:147], v[20:23], v[60:63], v[144:147]
G_39:
    s_cbranch_execz G_41
    ds_read_b128 v[44:47], v11 offset:24576
    v_max3_f32 v7, v7, v136, v137
    v_mfma_f32_16x16x32_bf16 v[148:151], v[24:27], v[60:63], v[148:151]
    ds_read_b128 v[48:51], v11 offset:28672
    s_waitcnt lgkmcnt(3)
    v_cmp_ne_u32 vcc, 0, v3
    v_mfma_f32_16x16x32_bf16 v[152:155], v[28:31], v[60:63], v[152:155]
    s_cbranch_vccnz C_37
R_38:
    ds_read_b128 v[68:71], v8 offset:32768
    v_mfma_f32_16x16x32_bf16 v[156:159], v[32:35], v[60:63], v[156:159]
    ds_read_b128 v[72:75], v8 offset:36864
    v_max3_f32 v7, v7, v138, v139
    s_waitcnt lgkmcnt(4)
    v_mfma_f32_16x16x32_bf16 v[144:147], v[36:39], v[64:67], v[144:147]
    ds_read_b128 v[76:79], v8 offset:40960
    v_max3_f32 v7, v7, v140, v141
    v_mfma_f32_16x16x32_bf16 v[148:151], v[40:43], v[64:67], v[148:151]
    ds_read_b128 v[80:83], v8 offset:45056
    v_max3_f32 v7, v7, v142, v143
    s_waitcnt lgkmcnt(4)
    v_mfma_f32_16x16x32_bf16 v[152:155], v[44:47], v[64:67], v[152:155]
    ds_read_b128 v[84:87], v9 offset:32768
    v_mfma_f32_16x16x32_bf16 v[156:159], v[48:51], v[64:67], v[156:159]
    ds_read_b128 v[88:91], v9 offset:36864
    buffer_load_dword off, s[72:75], 0 offset:172 lds
    s_waitcnt lgkmcnt(4)
    v_mfma_f32_16x16x32_bf16 v[160:163], v[68:71], v[52:55], 0
    ds_read_b128 v[92:95], v9 offset:40960
    v_mfma_f32_16x16x32_bf16 v[164:167], v[72:75], v[52:55], 0
    ds_read_b128 v[96:99], v9 offset:45056
    s_waitcnt lgkmcnt(4)
    v_mfma_f32_16x16x32_bf16 v[168:171], v[76:79], v[52:55], 0
    ds_read_b128 v[20:23], v10 offset:32768
    v_mfma_f32_16x16x32_bf16 v[172:175], v[80:83], v[52:55], 0
    ds_read_b128 v[24:27], v10 offset:36864
G_40:
    s_cbranch_execz G_42
    v_max3_f32 v7, v7, v144, v145
    s_waitcnt lgkmcnt(4)
    v_mfma_f32_16x16x32_bf16 v[160:163], v[84:87], v[56:59], v[160:163]
    ds_read_b128 v[28:31], v10 offset:40960
    v_max3_f32 v7, v7, v146, v147
    v_mfma_f32_16x16x32_bf16 v[164:167], v[88:91], v[56:59], v[164:167]
    ds_read_b128 v[32:35], v10 offset:45056
    v_max3_f32 v7, v7, v148, v149
    s_waitcnt lgkmcnt(4)
    v_mfma_f32_16x16x32_bf16 v[168:171], v[92:95], v[56:59], v[168:171]
    ds_read_b128 v[36:39], v11 offset:32768
    ds_read_b32 v3, v2 offset:2276
    v_mfma_f32_16x16x32_bf16 v[172:175], v[96:99], v[56:59], v[172:175]
    ds_read_b128 v[40:43], v11 offset:36864
    v_max3_f32 v7, v7, v150, v151
    s_waitcnt lgkmcnt(5)
    v_mfma_f32_16x16x32_bf16 v[160:163], v[20:23], v[60:63], v[160:163]
    ds_read_b128 v[44:47], v11 offset:40960
    v_max3_f32 v7, v7, v152, v153
    v_mfma_f32_16x16x32_bf16 v[164:167], v[24:27], v[60:63], v[164:167]
    ds_read_b128 v[48:51], v11 offset:45056
    s_waitcnt lgkmcnt(3)
    v_cmp_ne_u32 vcc, 0, v3
    v_mfma_f32_16x16x32_bf16 v[168:171], v[28:31], v[60:63], v[168:171]
    s_cbranch_vccnz C_39
R_40:
    ds_read_b128 v[68:71], v8 offset:49152
    v_mfma_f32_16x16x32_bf16 v[172:175], v[32:35], v[60:63], v[172:175]
    ds_read_b128 v[72:75], v8 offset:53248
    v_max3_f32 v7, v7, v154, v155
    s_waitcnt lgkmcnt(4)
    v_mfma_f32_16x16x32_bf16 v[160:163], v[36:39], v[64:67], v[160:163]
    ds_read_b128 v[76:79], v8 offset:57344
    v_max3_f32 v7, v7, v156, v157
    v_mfma_f32_16x16x32_bf16 v[164:167], v[40:43], v[64:67], v[164:167]
    ds_read_b128 v[80:83], v8 offset:61440
G_41:
    s_cbranch_execz G_43
    v_max3_f32 v7, v7, v158, v159
    s_waitcnt lgkmcnt(4)
    v_mfma_f32_16x16x32_bf16 v[168:171], v[44:47], v[64:67], v[168:171]
    ds_read_b128 v[84:87], v9 offset:49152
    v_mfma_f32_16x16x32_bf16 v[172:175], v[48:51], v[64:67], v[172:175]
    ds_read_b128 v[88:91], v9 offset:53248
    buffer_load_dword off, s[72:75], 0 offset:168 lds
    s_waitcnt lgkmcnt(4)
    v_mfma_f32_16x16x32_bf16 v[176:179], v[68:71], v[52:55], 0
    ds_read_b128 v[92:95], v9 offset:57344
    v_mfma_f32_16x16x32_bf16 v[180:183], v[72:75], v[52:55], 0
    ds_read_b128 v[96:99], v9 offset:61440
    s_waitcnt lgkmcnt(4)
    v_mfma_f32_16x16x32_bf16 v[184:187], v[76:79], v[52:55], 0
    ds_read_b128 v[20:23], v10 offset:49152
    v_mfma_f32_16x16x32_bf16 v[188:191], v[80:83], v[52:55], 0
    ds_read_b128 v[24:27], v10 offset:53248
    v_max3_f32 v7, v7, v160, v161
    s_waitcnt lgkmcnt(4)
    v_mfma_f32_16x16x32_bf16 v[176:179], v[84:87], v[56:59], v[176:179]
    ds_read_b128 v[28:31], v10 offset:57344
    v_max3_f32 v7, v7, v162, v163
    v_mfma_f32_16x16x32_bf16 v[180:183], v[88:91], v[56:59], v[180:183]
    ds_read_b128 v[32:35], v10 offset:61440
    v_max3_f32 v7, v7, v164, v165
    s_waitcnt lgkmcnt(4)
    v_mfma_f32_16x16x32_bf16 v[184:187], v[92:95], v[56:59], v[184:187]
    ds_read_b128 v[36:39], v11 offset:49152
    ds_read_b32 v3, v2 offset:2272
    v_mfma_f32_16x16x32_bf16 v[188:191], v[96:99], v[56:59], v[188:191]
    ds_read_b128 v[40:43], v11 offset:53248
    v_max3_f32 v7, v7, v166, v167
    s_waitcnt lgkmcnt(5)
    v_mfma_f32_16x16x32_bf16 v[176:179], v[20:23], v[60:63], v[176:179]
    ds_read_b128 v[44:47], v11 offset:57344
G_42:
    s_cbranch_execz G_44
    v_max3_f32 v7, v7, v168, v169
    v_mfma_f32_16x16x32_bf16 v[180:183], v[24:27], v[60:63], v[180:183]
    ds_read_b128 v[48:51], v11 offset:61440
    s_waitcnt lgkmcnt(3)
    v_cmp_ne_u32 vcc, 0, v3
    v_mfma_f32_16x16x32_bf16 v[184:187], v[28:31], v[60:63], v[184:187]
    s_cbranch_vccnz C_41
R_42:
    v_add_u32 v8, 65536, v8
    v_add_u32 v9, 65536, v9
    v_add_u32 v10, 65536, v10
    v_add_u32 v11, 65536, v11
    ds_read_b128 v[68:71], v8 offset:0
    v_mfma_f32_16x16x32_bf16 v[188:191], v[32:35], v[60:63], v[188:191]
    ds_read_b128 v[72:75], v8 offset:4096
    v_max3_f32 v7, v7, v170, v171
    s_waitcnt lgkmcnt(4)
    v_mfma_f32_16x16x32_bf16 v[176:179], v[36:39], v[64:67], v[176:179]
    ds_read_b128 v[76:79], v8 offset:8192
    v_max3_f32 v7, v7, v172, v173
    v_mfma_f32_16x16x32_bf16 v[180:183], v[40:43], v[64:67], v[180:183]
    ds_read_b128 v[80:83], v8 offset:12288
    v_max3_f32 v7, v7, v174, v175
    s_waitcnt lgkmcnt(4)
    v_mfma_f32_16x16x32_bf16 v[184:187], v[44:47], v[64:67], v[184:187]
    ds_read_b128 v[84:87], v9 offset:0
    v_mfma_f32_16x16x32_bf16 v[188:191], v[48:51], v[64:67], v[188:191]
    ds_read_b128 v[88:91], v9 offset:4096
    buffer_load_dword off, s[72:75], 0 offset:164 lds
    s_waitcnt lgkmcnt(4)
    v_mfma_f32_16x16x32_bf16 v[192:195], v[68:71], v[52:55], 0
    ds_read_b128 v[92:95], v9 offset:8192
    v_mfma_f32_16x16x32_bf16 v[196:199], v[72:75], v[52:55], 0
    ds_read_b128 v[96:99], v9 offset:12288
    s_waitcnt lgkmcnt(4)
    v_mfma_f32_16x16x32_bf16 v[200:203], v[76:79], v[52:55], 0
G_43:
    s_cbranch_execz G_45
    ds_read_b128 v[20:23], v10 offset:0
    v_max3_f32 v7, v7, v176, v177
    v_max3_f32 v7, v7, v178, v179
    v_max3_f32 v7, v7, v180, v181
    v_mfma_f32_16x16x32_bf16 v[204:207], v[80:83], v[52:55], 0
    ds_read_b128 v[24:27], v10 offset:4096
    v_max3_f32 v7, v7, v182, v183
    v_max3_f32 v7, v7, v184, v185
    v_max3_f32 v7, v7, v186, v187
    s_waitcnt lgkmcnt(4)
    v_mfma_f32_16x16x32_bf16 v[192:195], v[84:87], v[56:59], v[192:195]
    ds_read_b128 v[28:31], v10 offset:8192
    v_max3_f32 v7, v7, v188, v189
    v_max3_f32 v7, v7, v190, v191
    v_mfma_f32_16x16x32_bf16 v[196:199], v[88:91], v[56:59], v[196:199]
    ds_read_b128 v[32:35], v10 offset:12288
    v_mov_b32 v6, v7
    s_nop 1
    v_permlane32_swap_b32 v6, v7
    v_max_f32 v7, v6, v7
    s_waitcnt lgkmcnt(4)
    v_mfma_f32_16x16x32_bf16 v[200:203], v[92:95], v[56:59], v[200:203]
    ds_read_b128 v[36:39], v11 offset:0
    ds_read_b32 v3, v2 offset:2268
    v_mov_b32 v6, v7
    v_mfma_f32_16x16x32_bf16 v[204:207], v[96:99], v[56:59], v[204:207]
    ds_read_b128 v[40:43], v11 offset:4096
    v_permlane16_swap_b32 v6, v7
    v_max_f32 v7, v6, v7
    v_and_b32 v6, 0xffff0000, v7
    s_waitcnt lgkmcnt(5)
    v_mfma_f32_16x16x32_bf16 v[192:195], v[20:23], v[60:63], v[192:195]
    ds_read_b128 v[44:47], v11 offset:8192
    v_sub_f32 v5, v7, v6
    v_and_b32 v5, 0xffff0000, v5
    v_add_f32 v7, v6, v5
    v_mfma_f32_16x16x32_bf16 v[196:199], v[24:27], v[60:63], v[196:199]
G_44:
    s_cbranch_execz G_46
    ds_read_b128 v[48:51], v11 offset:12288
    v_cndmask_b32 v108, v5, v6, s[76:77]
    s_waitcnt lgkmcnt(3)
    v_cmp_ne_u32 vcc, 0, v3
    v_mfma_f32_16x16x32_bf16 v[200:203], v[28:31], v[60:63], v[200:203]
    s_cbranch_vccnz C_43
R_44:
    ds_read_b128 v[68:71], v8 offset:16384
    v_mfma_f32_16x16x32_bf16 v[204:207], v[32:35], v[60:63], v[204:207]
    ds_read_b128 v[72:75], v8 offset:20480
    v_lshrrev_b32 v108, 16, v108
    v_xor_b32 v108, 0x8000, v108
    v_mov_b32 v17, v7
    s_nop 0
    v_mfma_f32_32x32x16_bf16 v[128:143], v[104:107], v[108:111], v[128:143]
    s_waitcnt lgkmcnt(4)
    v_mfma_f32_16x16x32_bf16 v[192:195], v[36:39], v[64:67], v[192:195]
    ds_read_b128 v[76:79], v8 offset:24576
    v_mfma_f32_16x16x32_bf16 v[196:199], v[40:43], v[64:67], v[196:199]
    ds_read_b128 v[80:83], v8 offset:28672
    s_waitcnt lgkmcnt(4)
    v_mfma_f32_16x16x32_bf16 v[200:203], v[44:47], v[64:67], v[200:203]
    ds_read_b128 v[84:87], v9 offset:16384
    s_nop 3
    v_exp_f32 v128, v128
    v_exp_f32 v129, v129
    v_mfma_f32_16x16x32_bf16 v[204:207], v[48:51], v[64:67], v[204:207]
    ds_read_b128 v[88:91], v9 offset:20480
    buffer_load_dword off, s[72:75], 0 offset:160 lds
    s_waitcnt lgkmcnt(4)
    v_mfma_f32_16x16x32_bf16 v[208:211], v[68:71], v[52:55], 0
    ds_read_b128 v[92:95], v9 offset:24576
    v_exp_f32 v130, v130
    v_exp_f32 v131, v131
    v_mfma_f32_16x16x32_bf16 v[212:215], v[72:75], v[52:55], 0
    ds_read_b128 v[96:99], v9 offset:28672
    v_cvt_pk_bf16_f32 v128, v128, v129
    v_exp_f32 v132, v132
    v_exp_f32 v133, v133
    s_waitcnt lgkmcnt(4)
    v_mfma_f32_16x16x32_bf16 v[216:219], v[76:79], v[52:55], 0
G_45:
    s_cbranch_execz G_47
    ds_read_b128 v[20:23], v10 offset:16384
    v_cvt_pk_bf16_f32 v129, v130, v131
    v_exp_f32 v134, v134
    v_mfma_f32_16x16x32_bf16 v[220:223], v[80:83], v[52:55], 0
    ds_read_b128 v[24:27], v10 offset:20480
    v_exp_f32 v135, v135
    v_cvt_pk_bf16_f32 v130, v132, v133
    s_waitcnt lgkmcnt(4)
    v_mfma_f32_16x16x32_bf16 v[208:211], v[84:87], v[56:59], v[208:211]
    ds_read_b128 v[28:31], v10 offset:24576
    v_max3_f32 v7, v7, v192, v193
    v_exp_f32 v136, v136
    v_exp_f32 v137, v137
    v_mfma_f32_16x16x32_bf16 v[212:215], v[88:91], v[56:59], v[212:215]
    ds_read_b128 v[32:35], v10 offset:28672
    v_cvt_pk_bf16_f32 v131, v134, v135
    v_exp_f32 v138, v138
    s_waitcnt lgkmcnt(4)
    v_mfma_f32_16x16x32_bf16 v[216:219], v[92:95], v[56:59], v[216:219]
    ds_read_b128 v[36:39], v11 offset:16384
    v_exp_f32 v139, v139
    v_cvt_pk_bf16_f32 v132, v136, v137
    v_mfma_f32_16x16x32_bf16 v[220:223], v[96:99], v[56:59], v[220:223]
    ds_read_b128 v[40:43], v11 offset:20480
    ds_read_b32 v3, v2 offset:2264
    v_exp_f32 v140, v140
    v_exp_f32 v141, v141
    v_mfma_f32_32x32x16_bf16 v[144:159], v[104:107], v[108:111], v[144:159]
    v_max3_f32 v7, v7, v194, v195
    v_max3_f32 v7, v7, v196, v197
    v_max3_f32 v7, v7, v198, v199
    v_max3_f32 v7, v7, v200, v201
    v_max3_f32 v7, v7, v202, v203
    v_max3_f32 v7, v7, v204, v205
    v_cvt_pk_bf16_f32 v133, v138, v139
    v_exp_f32 v142, v142
    s_waitcnt lgkmcnt(5)
    v_mfma_f32_16x16x32_bf16 v[208:211], v[20:23], v[60:63], v[208:211]
G_46:
    s_cbranch_execz G_48
    ds_read_b128 v[44:47], v11 offset:24576
    v_max3_f32 v7, v7, v206, v207
    v_exp_f32 v143, v143
    v_cvt_pk_bf16_f32 v134, v140, v141
    v_mfma_f32_16x16x32_bf16 v[212:215], v[24:27], v[60:63], v[212:215]
    ds_read_b128 v[48:51], v11 offset:28672
    v_cvt_pk_bf16_f32 v135, v142, v143
    s_waitcnt lgkmcnt(2)
    v_cmp_ne_u32 vcc, 0, v3
    v_mfma_f32_16x16x32_bf16 v[216:219], v[28:31], v[60:63], v[216:219]
    s_cbranch_vccnz C_45
R_46:
    ds_read_b128 v[68:71], v8 offset:32768
    v_mfma_f32_16x16x32_bf16 v[220:223], v[32:35], v[60:63], v[220:223]
    ds_read_b128 v[72:75], v8 offset:36864
    v_exp_f32 v144, v144
    v_exp_f32 v145, v145
    v_mfma_f32_16x16x32_bf16 v[208:211], v[36:39], v[64:67], v[208:211]
    ds_read_b128 v[76:79], v8 offset:40960
    v_exp_f32 v146, v146
    v_mfma_f32_16x16x32_bf16 v[212:215], v[40:43], v[64:67], v[212:215]
    ds_read_b128 v[80:83], v8 offset:45056
    v_exp_f32 v147, v147
    v_cvt_pk_bf16_f32 v144, v144, v145
    s_waitcnt lgkmcnt(4)
    v_mfma_f32_16x16x32_bf16 v[216:219], v[44:47], v[64:67], v[216:219]
    ds_read_b128 v[84:87], v9 offset:32768
    v_exp_f32 v148, v148
    v_exp_f32 v149, v149
    v_mfma_f32_16x16x32_bf16 v[220:223], v[48:51], v[64:67], v[220:223]
    ds_read_b128 v[88:91], v9 offset:36864
    buffer_load_dword off, s[72:75], 0 offset:156 lds
    s_waitcnt lgkmcnt(4)
    v_mfma_f32_16x16x32_bf16 v[224:227], v[68:71], v[52:55], 0
    ds_read_b128 v[92:95], v9 offset:40960
    v_cvt_pk_bf16_f32 v145, v146, v147
    v_exp_f32 v150, v150
    v_mfma_f32_16x16x32_bf16 v[228:231], v[72:75], v[52:55], 0
    ds_read_b128 v[96:99], v9 offset:45056
G_47:
    s_cbranch_execz G_49
    v_exp_f32 v151, v151
    v_cvt_pk_bf16_f32 v146, v148, v149
    s_waitcnt lgkmcnt(4)
    v_mfma_f32_16x16x32_bf16 v[232:235], v[76:79], v[52:55], 0
    ds_read_b128 v[20:23], v10 offset:32768
    v_exp_f32 v152, v152
    v_exp_f32 v153, v153
    v_mfma_f32_16x16x32_bf16 v[236:239], v[80:83], v[52:55], 0
    ds_read_b128 v[24:27], v10 offset:36864
    v_cvt_pk_bf16_f32 v147, v150, v151
    v_exp_f32 v154, v154
    v_mfma_f32_32x32x16_bf16 v[160:175], v[104:107], v[108:111], v[160:175]
    v_max3_f32 v7, v7, v208, v209
    v_max3_f32 v7, v7, v210, v211
    v_max3_f32 v7, v7, v212, v213
    v_max3_f32 v7, v7, v214, v215
    v_max3_f32 v7, v7, v216, v217
    v_max3_f32 v7, v7, v218, v219
    v_max3_f32 v7, v7, v220, v221
    v_exp_f32 v155, v155
    v_cvt_pk_bf16_f32 v148, v152, v153
    s_waitcnt lgkmcnt(4)
    v_mfma_f32_16x16x32_bf16 v[224:227], v[84:87], v[56:59], v[224:227]
    ds_read_b128 v[28:31], v10 offset:40960
    v_exp_f32 v156, v156
    v_mfma_f32_16x16x32_bf16 v[228:231], v[88:91], v[56:59], v[228:231]
    ds_read_b128 v[32:35], v10 offset:45056
    v_exp_f32 v157, v157
    v_cvt_pk_bf16_f32 v149, v154, v155
    v_exp_f32 v158, v158
    s_waitcnt lgkmcnt(4)
    v_mfma_f32_16x16x32_bf16 v[232:235], v[92:95], v[56:59], v[232:235]
    ds_read_b128 v[36:39], v11 offset:32768
    ds_read_b32 v3, v2 offset:2260
    v_mfma_f32_16x16x32_bf16 v[236:239], v[96:99], v[56:59], v[236:239]
    ds_read_b128 v[40:43], v11 offset:36864
    v_exp_f32 v159, v159
G_48:
    s_cbranch_execz G_50
    v_cvt_pk_bf16_f32 v150, v156, v157
    v_cvt_pk_bf16_f32 v151, v158, v159
    s_waitcnt lgkmcnt(5)
    v_mfma_f32_16x16x32_bf16 v[224:227], v[20:23], v[60:63], v[224:227]
    ds_read_b128 v[44:47], v11 offset:40960
    v_max3_f32 v7, v7, v222, v223
    v_exp_f32 v160, v160
    v_mfma_f32_16x16x32_bf16 v[228:231], v[24:27], v[60:63], v[228:231]
    ds_read_b128 v[48:51], v11 offset:45056
    v_exp_f32 v161, v161
    s_waitcnt lgkmcnt(3)
    v_cmp_ne_u32 vcc, 0, v3
    v_mfma_f32_16x16x32_bf16 v[232:235], v[28:31], v[60:63], v[232:235]
    s_cbranch_vccnz C_47
R_48:
    ds_read_b128 v[68:71], v8 offset:49152
    v_exp_f32 v162, v162
    v_mfma_f32_16x16x32_bf16 v[236:239], v[32:35], v[60:63], v[236:239]
    ds_read_b128 v[72:75], v8 offset:53248
    v_exp_f32 v163, v163
    v_cvt_pk_bf16_f32 v160, v160, v161
    s_waitcnt lgkmcnt(4)
    v_mfma_f32_16x16x32_bf16 v[224:227], v[36:39], v[64:67], v[224:227]
    ds_read_b128 v[76:79], v8 offset:57344
    v_exp_f32 v164, v164
    v_exp_f32 v165, v165
    v_mfma_f32_16x16x32_bf16 v[228:231], v[40:43], v[64:67], v[228:231]
    ds_read_b128 v[80:83], v8 offset:61440
    v_cvt_pk_bf16_f32 v161, v162, v163
    v_exp_f32 v166, v166
    s_waitcnt lgkmcnt(4)
    v_mfma_f32_16x16x32_bf16 v[232:235], v[44:47], v[64:67], v[232:235]
    ds_read_b128 v[84:87], v9 offset:49152
    v_exp_f32 v167, v167
    v_cvt_pk_bf16_f32 v162, v164, v165
    v_mfma_f32_16x16x32_bf16 v[236:239], v[48:51], v[64:67], v[236:239]
    ds_read_b128 v[88:91], v9 offset:53248
    buffer_load_dword off, s[72:75], 0 offset:152 lds
    v_exp_f32 v168, v168
    v_mfma_f32_32x32x16_bf16 v[176:191], v[104:107], v[108:111], v[176:191]
G_49:
    s_cbranch_execz G_51
    v_exp_f32 v169, v169
    v_cvt_pk_bf16_f32 v163, v166, v167
    v_exp_f32 v170, v170
    v_exp_f32 v171, v171
    v_cvt_pk_bf16_f32 v164, v168, v169
    s_waitcnt lgkmcnt(4)
    v_mfma_f32_16x16x32_bf16 v[240:243], v[68:71], v[52:55], 0
    ds_read_b128 v[92:95], v9 offset:57344
    v_exp_f32 v172, v172
    v_exp_f32 v173, v173
    v_mfma_f32_16x16x32_bf16 v[244:247], v[72:75], v[52:55], 0
    ds_read_b128 v[96:99], v9 offset:61440
    v_cvt_pk_bf16_f32 v165, v170, v171
    v_exp_f32 v174, v174
    s_waitcnt lgkmcnt(4)
    v_mfma_f32_16x16x32_bf16 v[248:251], v[76:79], v[52:55], 0
    ds_read_b128 v[20:23], v10 offset:49152
    v_exp_f32 v175, v175
    v_cvt_pk_bf16_f32 v166, v172, v173
    v_cvt_pk_bf16_f32 v167, v174, v175
    v_mfma_f32_16x16x32_bf16 v[252:255], v[80:83], v[52:55], 0
    ds_read_b128 v[24:27], v10 offset:53248
    v_max3_f32 v7, v7, v224, v225
    v_max3_f32 v7, v7, v226, v227
    s_waitcnt lgkmcnt(4)
    v_mfma_f32_16x16x32_bf16 v[240:243], v[84:87], v[56:59], v[240:243]
    ds_read_b128 v[28:31], v10 offset:57344
    v_max3_f32 v7, v7, v228, v229
    v_max3_f32 v7, v7, v230, v231
    v_mfma_f32_16x16x32_bf16 v[244:247], v[88:91], v[56:59], v[244:247]
    ds_read_b128 v[32:35], v10 offset:61440
    v_max3_f32 v7, v7, v232, v233
    v_exp_f32 v176, v176
    v_exp_f32 v177, v177
    s_waitcnt lgkmcnt(4)
    v_mfma_f32_16x16x32_bf16 v[248:251], v[92:95], v[56:59], v[248:251]
    ds_read_b128 v[36:39], v11 offset:49152
    ds_read_b32 v3, v2 offset:2256
G_50:
    s_cbranch_execz G_52
    v_max3_f32 v7, v7, v234, v235
    v_exp_f32 v178, v178
    v_mfma_f32_16x16x32_bf16 v[252:255], v[96:99], v[56:59], v[252:255]
    ds_read_b128 v[40:43], v11 offset:53248
    v_max3_f32 v7, v7, v236, v237
    v_exp_f32 v179, v179
    v_cvt_pk_bf16_f32 v176, v176, v177
    s_waitcnt lgkmcnt(5)
    v_mfma_f32_16x16x32_bf16 v[240:243], v[20:23], v[60:63], v[240:243]
    ds_read_b128 v[44:47], v11 offset:57344
    v_max3_f32 v7, v7, v238, v239
    v_exp_f32 v180, v180
    v_exp_f32 v181, v181
    v_cvt_pk_bf16_f32 v177, v178, v179
    v_mfma_f32_16x16x32_bf16 v[244:247], v[24:27], v[60:63], v[244:247]
    ds_read_b128 v[48:51], v11 offset:61440
    v_exp_f32 v182, v182
    s_waitcnt lgkmcnt(3)
    v_cmp_ne_u32 vcc, 0, v3
    v_mfma_f32_16x16x32_bf16 v[248:251], v[28:31], v[60:63], v[248:251]
    v_mov_b32 v8, v114
    v_xor_b32 v9, 32, v114
    v_xor_b32 v10, 64, v114
    v_xor_b32 v11, 96, v114
    v_xor_b32 v12, 128, v114
    v_xor_b32 v13, 160, v114
    v_xor_b32 v14, 192, v114
    v_xor_b32 v15, 224, v114
    s_cbranch_vccnz C_49
R_50:
    v_add_u32 v8, 131072, v8
    v_add_u32 v9, 131072, v9
    v_add_u32 v10, 131072, v10
    v_add_u32 v11, 131072, v11
    v_add_u32 v12, 131072, v12
    v_add_u32 v13, 131072, v13
    v_add_u32 v14, 131072, v14
    v_add_u32 v15, 131072, v15
    ds_read_b64_tr_b16 v[68:69], v8 offset:0
G_51:
    s_cbranch_execz G_53
    ds_read_b64_tr_b16 v[70:71], v8 offset:4096
    v_mfma_f32_16x16x32_bf16 v[252:255], v[32:35], v[60:63], v[252:255]
    ds_read_b64_tr_b16 v[72:73], v9 offset:0
    ds_read_b64_tr_b16 v[74:75], v9 offset:4096
    v_exp_f32 v183, v183
    v_cvt_pk_bf16_f32 v178, v180, v181
    s_waitcnt lgkmcnt(6)
    v_mfma_f32_16x16x32_bf16 v[240:243], v[36:39], v[64:67], v[240:243]
    ds_read_b64_tr_b16 v[76:77], v10 offset:0
    ds_read_b64_tr_b16 v[78:79], v10 offset:4096
    v_exp_f32 v184, v184
    v_exp_f32 v185, v185
    v_mfma_f32_16x16x32_bf16 v[244:247], v[40:43], v[64:67], v[244:247]
    ds_read_b64_tr_b16 v[80:81], v11 offset:0
    ds_read_b64_tr_b16 v[82:83], v11 offset:4096
    v_cvt_pk_bf16_f32 v179, v182, v183
    v_exp_f32 v186, v186
    s_waitcnt lgkmcnt(8)
    v_mfma_f32_16x16x32_bf16 v[248:251], v[44:47], v[64:67], v[248:251]
    ds_read_b64_tr_b16 v[84:85], v12 offset:0
    ds_read_b64_tr_b16 v[86:87], v12 offset:4096
    v_exp_f32 v187, v187
    v_cvt_pk_bf16_f32 v180, v184, v185
    v_mfma_f32_16x16x32_bf16 v[252:255], v[48:51], v[64:67], v[252:255]
    ds_read_b64_tr_b16 v[88:89], v13 offset:0
    ds_read_b64_tr_b16 v[90:91], v13 offset:4096
    buffer_load_dword off, s[72:75], 0 offset:148 lds
    s_waitcnt lgkmcnt(8)
    v_mfma_f32_16x16x32_bf16 v[20:23], v[68:71], v[128:131], 0
    ds_read_b64_tr_b16 v[92:93], v14 offset:0
    ds_read_b64_tr_b16 v[94:95], v14 offset:4096
    v_exp_f32 v188, v188
    v_exp_f32 v189, v189
    v_mfma_f32_16x16x32_bf16 v[100:103], v[104:107], v[128:131], 0
    v_cvt_pk_bf16_f32 v181, v186, v187
    v_exp_f32 v190, v190
    v_exp_f32 v191, v191
G_52:
    s_cbranch_execz G_54
    v_cvt_pk_bf16_f32 v182, v188, v189
    v_cvt_pk_bf16_f32 v183, v190, v191
    v_mfma_f32_16x16x32_bf16 v[24:27], v[72:75], v[128:131], 0
    ds_read_b64_tr_b16 v[96:97], v15 offset:0
    ds_read_b64_tr_b16 v[98:99], v15 offset:4096
    s_waitcnt lgkmcnt(8)
    v_mfma_f32_16x16x32_bf16 v[28:31], v[76:79], v[128:131], 0
    ds_read_b64_tr_b16 v[68:69], v8 offset:8192
    ds_read_b64_tr_b16 v[70:71], v8 offset:12288
    v_max3_f32 v7, v7, v240, v241
    v_max3_f32 v7, v7, v242, v243
    v_max3_f32 v7, v7, v244, v245
    v_mfma_f32_16x16x32_bf16 v[32:35], v[80:83], v[128:131], 0
    ds_read_b64_tr_b16 v[72:73], v9 offset:8192
    ds_read_b64_tr_b16 v[74:75], v9 offset:12288
    v_max3_f32 v7, v7, v246, v247
    v_max3_f32 v7, v7, v248, v249
    s_waitcnt lgkmcnt(8)
    v_mfma_f32_16x16x32_bf16 v[36:39], v[84:87], v[128:131], 0
    ds_read_b64_tr_b16 v[76:77], v10 offset:8192
    ds_read_b64_tr_b16 v[78:79], v10 offset:12288
    v_max3_f32 v7, v7, v250, v251
    v_max3_f32 v7, v7, v252, v253
    v_max3_f32 v7, v7, v254, v255
    v_mfma_f32_16x16x32_bf16 v[40:43], v[88:91], v[128:131], 0
    ds_read_b64_tr_b16 v[80:81], v11 offset:8192
    ds_read_b64_tr_b16 v[82:83], v11 offset:12288
    v_mov_b32 v6, v7
    s_nop 1
    v_permlane32_swap_b32 v6, v7
    s_waitcnt lgkmcnt(8)
    v_mfma_f32_16x16x32_bf16 v[44:47], v[92:95], v[128:131], 0
    ds_read_b64_tr_b16 v[84:85], v12 offset:8192
    ds_read_b64_tr_b16 v[86:87], v12 offset:12288
    v_max_f32 v7, v6, v7
G_53:
    s_cbranch_execz G_55
    v_mov_b32 v6, v7
    s_nop 1
    v_permlane16_swap_b32 v6, v7
    v_mfma_f32_16x16x32_bf16 v[48:51], v[96:99], v[128:131], 0
    ds_read_b64_tr_b16 v[88:89], v13 offset:8192
    ds_read_b64_tr_b16 v[90:91], v13 offset:12288
    ds_read_b32 v3, v2 offset:2252
    v_max_f32 v7, v6, v7
    s_waitcnt lgkmcnt(9)
    v_mfma_f32_16x16x32_bf16 v[20:23], v[68:71], v[132:135], v[20:23]
    ds_read_b64_tr_b16 v[92:93], v14 offset:8192
    ds_read_b64_tr_b16 v[94:95], v14 offset:12288
    v_and_b32 v6, 0xffff0000, v7
    v_sub_f32 v5, v7, v6
    v_mfma_f32_16x16x32_bf16 v[100:103], v[104:107], v[132:135], v[100:103]
    v_and_b32 v5, 0xffff0000, v5
    v_add_f32 v7, v6, v5
    v_cndmask_b32 v108, v5, v6, s[76:77]
    v_lshrrev_b32 v108, 16, v108
    v_xor_b32 v108, 0x8000, v108
    v_sub_f32 v17, v17, v7
    v_mfma_f32_16x16x32_bf16 v[24:27], v[72:75], v[132:135], v[24:27]
    ds_read_b64_tr_b16 v[96:97], v15 offset:8192
    ds_read_b64_tr_b16 v[98:99], v15 offset:12288
    s_waitcnt lgkmcnt(4)
    v_cmp_ne_u32 vcc, 0, v3
    v_mfma_f32_16x16x32_bf16 v[28:31], v[76:79], v[132:135], v[28:31]
    s_cbranch_vccnz C_51
R_52:
    v_subrev_u32 v8, 131072, v8
    v_subrev_u32 v9, 131072, v9
    v_subrev_u32 v10, 131072, v10
    v_subrev_u32 v11, 131072, v11
    v_subrev_u32 v12, 131072, v12
    v_subrev_u32 v13, 131072, v13
    v_subrev_u32 v14, 131072, v14
    v_subrev_u32 v15, 131072, v15
    ds_read_b64_tr_b16 v[68:69], v8 offset:0
    ds_read_b64_tr_b16 v[70:71], v8 offset:4096
G_54:
    s_cbranch_execz G_56
    v_exp_f32 v17, v17
    v_mfma_f32_16x16x32_bf16 v[32:35], v[80:83], v[132:135], v[32:35]
    ds_read_b64_tr_b16 v[72:73], v9 offset:0
    ds_read_b64_tr_b16 v[74:75], v9 offset:4096
    v_mfma_f32_32x32x16_bf16 v[192:207], v[104:107], v[108:111], v[192:207]
    v_mfma_f32_16x16x32_bf16 v[36:39], v[84:87], v[132:135], v[36:39]
    ds_read_b64_tr_b16 v[76:77], v10 offset:0
    ds_read_b64_tr_b16 v[78:79], v10 offset:4096
    v_mfma_f32_16x16x32_bf16 v[40:43], v[88:91], v[132:135], v[40:43]
    ds_read_b64_tr_b16 v[80:81], v11 offset:0
    ds_read_b64_tr_b16 v[82:83], v11 offset:4096
    s_waitcnt lgkmcnt(8)
    v_mfma_f32_16x16x32_bf16 v[44:47], v[92:95], v[132:135], v[44:47]
    ds_read_b64_tr_b16 v[84:85], v12 offset:0
    ds_read_b64_tr_b16 v[86:87], v12 offset:4096
    s_nop 1
    v_exp_f32 v192, v192
    v_mfma_f32_16x16x32_bf16 v[48:51], v[96:99], v[132:135], v[48:51]
    ds_read_b64_tr_b16 v[88:89], v13 offset:0
    ds_read_b64_tr_b16 v[90:91], v13 offset:4096
    buffer_load_dword off, s[72:75], 0 offset:144 lds
    s_waitcnt lgkmcnt(8)
    v_mfma_f32_16x16x32_bf16 v[20:23], v[68:71], v[144:147], v[20:23]
    ds_read_b64_tr_b16 v[92:93], v14 offset:0
    ds_read_b64_tr_b16 v[94:95], v14 offset:4096
    v_mfma_f32_16x16x32_bf16 v[100:103], v[104:107], v[144:147], v[100:103]
    v_exp_f32 v193, v193
    v_exp_f32 v194, v194
    v_exp_f32 v195, v195
    v_mfma_f32_16x16x32_bf16 v[24:27], v[72:75], v[144:147], v[24:27]
    ds_read_b64_tr_b16 v[96:97], v15 offset:0
    ds_read_b64_tr_b16 v[98:99], v15 offset:4096
    v_cvt_pk_bf16_f32 v192, v192, v193
    s_waitcnt lgkmcnt(8)
    v_mfma_f32_16x16x32_bf16 v[28:31], v[76:79], v[144:147], v[28:31]
    ds_read_b64_tr_b16 v[68:69], v8 offset:8192
G_55:
    s_cbranch_execz G_57
    ds_read_b64_tr_b16 v[70:71], v8 offset:12288
    v_mfma_f32_16x16x32_bf16 v[32:35], v[80:83], v[144:147], v[32:35]
    ds_read_b64_tr_b16 v[72:73], v9 offset:8192
    ds_read_b64_tr_b16 v[74:75], v9 offset:12288
    v_exp_f32 v196, v196
    s_waitcnt lgkmcnt(8)
    v_mfma_f32_16x16x32_bf16 v[36:39], v[84:87], v[144:147], v[36:39]
    ds_read_b64_tr_b16 v[76:77], v10 offset:8192
    ds_read_b64_tr_b16 v[78:79], v10 offset:12288
    v_exp_f32 v197, v197
    v_mfma_f32_16x16x32_bf16 v[40:43], v[88:91], v[144:147], v[40:43]
    ds_read_b64_tr_b16 v[80:81], v11 offset:8192
    ds_read_b64_tr_b16 v[82:83], v11 offset:12288
    v_cvt_pk_bf16_f32 v193, v194, v195
    s_waitcnt lgkmcnt(8)
    v_mfma_f32_16x16x32_bf16 v[44:47], v[92:95], v[144:147], v[44:47]
    ds_read_b64_tr_b16 v[84:85], v12 offset:8192
    ds_read_b64_tr_b16 v[86:87], v12 offset:12288
    v_mfma_f32_16x16x32_bf16 v[48:51], v[96:99], v[144:147], v[48:51]
    ds_read_b64_tr_b16 v[88:89], v13 offset:8192
    ds_read_b64_tr_b16 v[90:91], v13 offset:12288
    ds_read_b32 v3, v2 offset:2248
    s_waitcnt lgkmcnt(9)
    v_mfma_f32_16x16x32_bf16 v[20:23], v[68:71], v[148:151], v[20:23]
    ds_read_b64_tr_b16 v[92:93], v14 offset:8192
    ds_read_b64_tr_b16 v[94:95], v14 offset:12288
    v_exp_f32 v198, v198
    v_mfma_f32_16x16x32_bf16 v[100:103], v[104:107], v[148:151], v[100:103]
    v_exp_f32 v199, v199
    v_cvt_pk_bf16_f32 v194, v196, v197
    v_exp_f32 v200, v200
    v_mfma_f32_16x16x32_bf16 v[24:27], v[72:75], v[148:151], v[24:27]
    ds_read_b64_tr_b16 v[96:97], v15 offset:8192
    ds_read_b64_tr_b16 v[98:99], v15 offset:12288
    s_waitcnt lgkmcnt(4)
    v_cmp_ne_u32 vcc, 0, v3
G_56:
    s_cbranch_execz G_58
    v_mfma_f32_16x16x32_bf16 v[28:31], v[76:79], v[148:151], v[28:31]
    s_cbranch_vccnz C_53
R_54:
    ds_read_b64_tr_b16 v[68:69], v8 offset:16384
    ds_read_b64_tr_b16 v[70:71], v8 offset:20480
    v_mfma_f32_16x16x32_bf16 v[32:35], v[80:83], v[148:151], v[32:35]
    ds_read_b64_tr_b16 v[72:73], v9 offset:16384
    ds_read_b64_tr_b16 v[74:75], v9 offset:20480
    v_exp_f32 v201, v201
    v_mfma_f32_16x16x32_bf16 v[36:39], v[84:87], v[148:151], v[36:39]
    ds_read_b64_tr_b16 v[76:77], v10 offset:16384
    ds_read_b64_tr_b16 v[78:79], v10 offset:20480
    v_mfma_f32_16x16x32_bf16 v[40:43], v[88:91], v[148:151], v[40:43]
    ds_read_b64_tr_b16 v[80:81], v11 offset:16384
    ds_read_b64_tr_b16 v[82:83], v11 offset:20480
    v_cvt_pk_bf16_f32 v195, v198, v199
    v_mfma_f32_32x32x16_bf16 v[208:223], v[104:107], v[108:111], v[208:223]
    v_exp_f32 v202, v202
    v_exp_f32 v203, v203
    v_cvt_pk_bf16_f32 v196, v200, v201
    v_exp_f32 v204, v204
    v_exp_f32 v205, v205
    s_waitcnt lgkmcnt(8)
    v_mfma_f32_16x16x32_bf16 v[44:47], v[92:95], v[148:151], v[44:47]
    ds_read_b64_tr_b16 v[84:85], v12 offset:16384
    ds_read_b64_tr_b16 v[86:87], v12 offset:20480
    v_cvt_pk_bf16_f32 v197, v202, v203
    v_mfma_f32_16x16x32_bf16 v[48:51], v[96:99], v[148:151], v[48:51]
    ds_read_b64_tr_b16 v[88:89], v13 offset:16384
    ds_read_b64_tr_b16 v[90:91], v13 offset:20480
    buffer_load_dword off, s[72:75], 0 offset:140 lds
    s_waitcnt lgkmcnt(8)
    v_mfma_f32_16x16x32_bf16 v[20:23], v[68:71], v[160:163], v[20:23]
    ds_read_b64_tr_b16 v[92:93], v14 offset:16384
    ds_read_b64_tr_b16 v[94:95], v14 offset:20480
    v_exp_f32 v206, v206
    v_mfma_f32_16x16x32_bf16 v[100:103], v[104:107], v[160:163], v[100:103]
G_57:
    s_cbranch_execz G_59
    v_exp_f32 v207, v207
    v_cvt_pk_bf16_f32 v198, v204, v205
    v_cvt_pk_bf16_f32 v199, v206, v207
    v_mfma_f32_16x16x32_bf16 v[24:27], v[72:75], v[160:163], v[24:27]
    ds_read_b64_tr_b16 v[96:97], v15 offset:16384
    ds_read_b64_tr_b16 v[98:99], v15 offset:20480
    s_waitcnt lgkmcnt(8)
    v_mfma_f32_16x16x32_bf16 v[28:31], v[76:79], v[160:163], v[28:31]
    ds_read_b64_tr_b16 v[68:69], v8 offset:24576
    ds_read_b64_tr_b16 v[70:71], v8 offset:28672
    v_exp_f32 v208, v208
    v_mfma_f32_16x16x32_bf16 v[32:35], v[80:83], v[160:163], v[32:35]
    ds_read_b64_tr_b16 v[72:73], v9 offset:24576
    ds_read_b64_tr_b16 v[74:75], v9 offset:28672
    v_exp_f32 v209, v209
    s_waitcnt lgkmcnt(8)
    v_mfma_f32_16x16x32_bf16 v[36:39], v[84:87], v[160:163], v[36:39]
    ds_read_b64_tr_b16 v[76:77], v10 offset:24576
    ds_read_b64_tr_b16 v[78:79], v10 offset:28672
    v_mfma_f32_16x16x32_bf16 v[40:43], v[88:91], v[160:163], v[40:43]
    ds_read_b64_tr_b16 v[80:81], v11 offset:24576
    ds_read_b64_tr_b16 v[82:83], v11 offset:28672
    v_exp_f32 v210, v210
    s_waitcnt lgkmcnt(8)
    v_mfma_f32_16x16x32_bf16 v[44:47], v[92:95], v[160:163], v[44:47]
    ds_read_b64_tr_b16 v[84:85], v12 offset:24576
    ds_read_b64_tr_b16 v[86:87], v12 offset:28672
    v_exp_f32 v211, v211
    v_mfma_f32_16x16x32_bf16 v[48:51], v[96:99], v[160:163], v[48:51]
    ds_read_b64_tr_b16 v[88:89], v13 offset:24576
    ds_read_b64_tr_b16 v[90:91], v13 offset:28672
    ds_read_b32 v3, v2 offset:2244
    s_waitcnt lgkmcnt(9)
    v_mfma_f32_16x16x32_bf16 v[20:23], v[68:71], v[164:167], v[20:23]
    ds_read_b64_tr_b16 v[92:93], v14 offset:24576
    ds_read_b64_tr_b16 v[94:95], v14 offset:28672
G_58:
    s_cbranch_execz G_60
    v_cvt_pk_bf16_f32 v208, v208, v209
    v_mfma_f32_16x16x32_bf16 v[100:103], v[104:107], v[164:167], v[100:103]
    v_exp_f32 v212, v212
    v_exp_f32 v213, v213
    v_cvt_pk_bf16_f32 v209, v210, v211
    v_mfma_f32_16x16x32_bf16 v[24:27], v[72:75], v[164:167], v[24:27]
    ds_read_b64_tr_b16 v[96:97], v15 offset:24576
    ds_read_b64_tr_b16 v[98:99], v15 offset:28672
    s_waitcnt lgkmcnt(4)
    v_cmp_ne_u32 vcc, 0, v3
    v_mfma_f32_16x16x32_bf16 v[28:31], v[76:79], v[164:167], v[28:31]
    s_cbranch_vccnz C_55
R_56:
    ds_read_b64_tr_b16 v[68:69], v8 offset:32768
    ds_read_b64_tr_b16 v[70:71], v8 offset:36864
    v_mfma_f32_16x16x32_bf16 v[32:35], v[80:83], v[164:167], v[32:35]
    ds_read_b64_tr_b16 v[72:73], v9 offset:32768
    ds_read_b64_tr_b16 v[74:75], v9 offset:36864
    v_exp_f32 v214, v214
    v_mfma_f32_16x16x32_bf16 v[36:39], v[84:87], v[164:167], v[36:39]
    ds_read_b64_tr_b16 v[76:77], v10 offset:32768
    ds_read_b64_tr_b16 v[78:79], v10 offset:36864
    v_exp_f32 v215, v215
    v_mfma_f32_16x16x32_bf16 v[40:43], v[88:91], v[164:167], v[40:43]
    ds_read_b64_tr_b16 v[80:81], v11 offset:32768
    ds_read_b64_tr_b16 v[82:83], v11 offset:36864
    v_cvt_pk_bf16_f32 v210, v212, v213
    s_waitcnt lgkmcnt(8)
    v_mfma_f32_16x16x32_bf16 v[44:47], v[92:95], v[164:167], v[44:47]
    ds_read_b64_tr_b16 v[84:85], v12 offset:32768
    ds_read_b64_tr_b16 v[86:87], v12 offset:36864
    v_exp_f32 v216, v216
    v_mfma_f32_16x16x32_bf16 v[48:51], v[96:99], v[164:167], v[48:51]
    ds_read_b64_tr_b16 v[88:89], v13 offset:32768
    ds_read_b64_tr_b16 v[90:91], v13 offset:36864
    buffer_load_dword off, s[72:75], 0 offset:136 lds
    v_mfma_f32_32x32x16_bf16 v[224:239], v[104:107], v[108:111], v[224:239]
G_59:
    s_cbranch_execz G_61
    v_exp_f32 v217, v217
    v_cvt_pk_bf16_f32 v211, v214, v215
    v_exp_f32 v218, v218
    v_exp_f32 v219, v219
    v_cvt_pk_bf16_f32 v212, v216, v217
    s_waitcnt lgkmcnt(8)
    v_mfma_f32_16x16x32_bf16 v[20:23], v[68:71], v[176:179], v[20:23]
    ds_read_b64_tr_b16 v[92:93], v14 offset:32768
    ds_read_b64_tr_b16 v[94:95], v14 offset:36864
    v_exp_f32 v220, v220
    v_mfma_f32_16x16x32_bf16 v[100:103], v[104:107], v[176:179], v[100:103]
    v_exp_f32 v221, v221
    v_cvt_pk_bf16_f32 v213, v218, v219
    v_exp_f32 v222, v222
    v_mfma_f32_16x16x32_bf16 v[24:27], v[72:75], v[176:179], v[24:27]
    ds_read_b64_tr_b16 v[96:97], v15 offset:32768
    ds_read_b64_tr_b16 v[98:99], v15 offset:36864
    v_exp_f32 v223, v223
    s_waitcnt lgkmcnt(8)
    v_mfma_f32_16x16x32_bf16 v[28:31], v[76:79], v[176:179], v[28:31]
    ds_read_b64_tr_b16 v[68:69], v8 offset:40960
    ds_read_b64_tr_b16 v[70:71], v8 offset:45056
    v_cvt_pk_bf16_f32 v214, v220, v221
    v_mfma_f32_16x16x32_bf16 v[32:35], v[80:83], v[176:179], v[32:35]
    ds_read_b64_tr_b16 v[72:73], v9 offset:40960
    ds_read_b64_tr_b16 v[74:75], v9 offset:45056
    v_cvt_pk_bf16_f32 v215, v222, v223
    s_waitcnt lgkmcnt(8)
    v_mfma_f32_16x16x32_bf16 v[36:39], v[84:87], v[176:179], v[36:39]
    ds_read_b64_tr_b16 v[76:77], v10 offset:40960
    ds_read_b64_tr_b16 v[78:79], v10 offset:45056
    v_mfma_f32_16x16x32_bf16 v[40:43], v[88:91], v[176:179], v[40:43]
    ds_read_b64_tr_b16 v[80:81], v11 offset:40960
    ds_read_b64_tr_b16 v[82:83], v11 offset:45056
    s_waitcnt lgkmcnt(8)
    v_mfma_f32_16x16x32_bf16 v[44:47], v[92:95], v[176:179], v[44:47]
    ds_read_b64_tr_b16 v[84:85], v12 offset:40960
G_60:
    s_cbranch_execz G_62
    ds_read_b64_tr_b16 v[86:87], v12 offset:45056
    v_mfma_f32_16x16x32_bf16 v[48:51], v[96:99], v[176:179], v[48:51]
    ds_read_b64_tr_b16 v[88:89], v13 offset:40960
    ds_read_b64_tr_b16 v[90:91], v13 offset:45056
    ds_read_b32 v3, v2 offset:2240
    s_waitcnt lgkmcnt(9)
    v_mfma_f32_16x16x32_bf16 v[20:23], v[68:71], v[180:183], v[20:23]
    ds_read_b64_tr_b16 v[92:93], v14 offset:40960
    ds_read_b64_tr_b16 v[94:95], v14 offset:45056
    v_exp_f32 v224, v224
    v_exp_f32 v225, v225
    v_mfma_f32_16x16x32_bf16 v[100:103], v[104:107], v[180:183], v[100:103]
    v_exp_f32 v226, v226
    v_exp_f32 v227, v227
    v_cvt_pk_bf16_f32 v224, v224, v225
    v_mfma_f32_16x16x32_bf16 v[24:27], v[72:75], v[180:183], v[24:27]
    ds_read_b64_tr_b16 v[96:97], v15 offset:40960
    ds_read_b64_tr_b16 v[98:99], v15 offset:45056
    s_waitcnt lgkmcnt(4)
    v_cmp_ne_u32 vcc, 0, v3
    v_mfma_f32_16x16x32_bf16 v[28:31], v[76:79], v[180:183], v[28:31]
    s_cbranch_vccnz C_57
R_58:
    ds_read_b64_tr_b16 v[68:69], v8 offset:49152
    ds_read_b64_tr_b16 v[70:71], v8 offset:53248
    v_mfma_f32_16x16x32_bf16 v[32:35], v[80:83], v[180:183], v[32:35]
    ds_read_b64_tr_b16 v[72:73], v9 offset:49152
    ds_read_b64_tr_b16 v[74:75], v9 offset:53248
    v_exp_f32 v228, v228
    v_mfma_f32_16x16x32_bf16 v[36:39], v[84:87], v[180:183], v[36:39]
    ds_read_b64_tr_b16 v[76:77], v10 offset:49152
    ds_read_b64_tr_b16 v[78:79], v10 offset:53248
    v_exp_f32 v229, v229
    v_cvt_pk_bf16_f32 v225, v226, v227
    v_mfma_f32_16x16x32_bf16 v[40:43], v[88:91], v[180:183], v[40:43]
    ds_read_b64_tr_b16 v[80:81], v11 offset:49152
    ds_read_b64_tr_b16 v[82:83], v11 offset:53248
    v_exp_f32 v230, v230
G_61:
    s_cbranch_execz G_63
    s_waitcnt lgkmcnt(8)
    v_mfma_f32_16x16x32_bf16 v[44:47], v[92:95], v[180:183], v[44:47]
    ds_read_b64_tr_b16 v[84:85], v12 offset:49152
    ds_read_b64_tr_b16 v[86:87], v12 offset:53248
    v_exp_f32 v231, v231
    v_mfma_f32_16x16x32_bf16 v[48:51], v[96:99], v[180:183], v[48:51]
    ds_read_b64_tr_b16 v[88:89], v13 offset:49152
    ds_read_b64_tr_b16 v[90:91], v13 offset:53248
    buffer_load_dword off, s[72:75], 0 offset:132 lds
    v_mul_f32 v20, v20, v17
    v_mul_f32 v21, v21, v17
    v_mul_f32 v22, v22, v17
    v_mul_f32 v23, v23, v17
    v_mul_f32 v100, v100, v17
    s_waitcnt lgkmcnt(8)
    v_mfma_f32_16x16x32_bf16 v[20:23], v[68:71], v[192:195], v[20:23]
    ds_read_b64_tr_b16 v[92:93], v14 offset:49152
    ds_read_b64_tr_b16 v[94:95], v14 offset:53248
    v_mul_f32 v24, v24, v17
    v_mul_f32 v25, v25, v17
    v_mul_f32 v26, v26, v17
    v_mul_f32 v27, v27, v17
    v_mfma_f32_16x16x32_bf16 v[100:103], v[104:107], v[192:195], v[100:103]
    v_cvt_pk_bf16_f32 v226, v228, v229
    v_exp_f32 v232, v232
    v_exp_f32 v233, v233
    v_cvt_pk_bf16_f32 v227, v230, v231
    v_mfma_f32_16x16x32_bf16 v[24:27], v[72:75], v[192:195], v[24:27]
    ds_read_b64_tr_b16 v[96:97], v15 offset:49152
    ds_read_b64_tr_b16 v[98:99], v15 offset:53248
    v_mul_f32 v28, v28, v17
    v_mul_f32 v29, v29, v17
    v_mul_f32 v30, v30, v17
    v_mul_f32 v31, v31, v17
    v_mfma_f32_32x32x16_bf16 v[240:255], v[104:107], v[108:111], v[240:255]
    v_mul_f32 v32, v32, v17
    v_mul_f32 v33, v33, v17
    v_mul_f32 v34, v34, v17
    v_mul_f32 v35, v35, v17
    v_exp_f32 v234, v234
    v_exp_f32 v235, v235
    v_cvt_pk_bf16_f32 v228, v232, v233
    s_waitcnt lgkmcnt(8)
    v_mfma_f32_16x16x32_bf16 v[28:31], v[76:79], v[192:195], v[28:31]
G_62:
    s_cbranch_execz G_64
    ds_read_b64_tr_b16 v[68:69], v8 offset:57344
    ds_read_b64_tr_b16 v[70:71], v8 offset:61440
    v_mul_f32 v36, v36, v17
    v_mul_f32 v37, v37, v17
    v_mul_f32 v38, v38, v17
    v_mul_f32 v39, v39, v17
    v_mfma_f32_16x16x32_bf16 v[32:35], v[80:83], v[192:195], v[32:35]
    ds_read_b64_tr_b16 v[72:73], v9 offset:57344
    ds_read_b64_tr_b16 v[74:75], v9 offset:61440
    v_mul_f32 v40, v40, v17
    v_mul_f32 v41, v41, v17
    v_mul_f32 v42, v42, v17
    v_mul_f32 v43, v43, v17
    s_waitcnt lgkmcnt(8)
    v_mfma_f32_16x16x32_bf16 v[36:39], v[84:87], v[192:195], v[36:39]
    ds_read_b64_tr_b16 v[76:77], v10 offset:57344
    ds_read_b64_tr_b16 v[78:79], v10 offset:61440
    v_mul_f32 v44, v44, v17
    v_mul_f32 v45, v45, v17
    v_mul_f32 v46, v46, v17
    v_mul_f32 v47, v47, v17
    v_mfma_f32_16x16x32_bf16 v[40:43], v[88:91], v[192:195], v[40:43]
    ds_read_b64_tr_b16 v[80:81], v11 offset:57344
    ds_read_b64_tr_b16 v[82:83], v11 offset:61440
    v_mul_f32 v48, v48, v17
    v_mul_f32 v49, v49, v17
    v_mul_f32 v50, v50, v17
    v_mul_f32 v51, v51, v17
    s_waitcnt lgkmcnt(8)
    v_mfma_f32_16x16x32_bf16 v[44:47], v[92:95], v[192:195], v[44:47]
    ds_read_b64_tr_b16 v[84:85], v12 offset:57344
    ds_read_b64_tr_b16 v[86:87], v12 offset:61440
    v_exp_f32 v236, v236
    v_exp_f32 v237, v237
    v_mfma_f32_16x16x32_bf16 v[48:51], v[96:99], v[192:195], v[48:51]
    ds_read_b64_tr_b16 v[88:89], v13 offset:57344
    ds_read_b64_tr_b16 v[90:91], v13 offset:61440
    ds_read_b32 v3, v2 offset:2236
    s_waitcnt lgkmcnt(9)
    v_mfma_f32_16x16x32_bf16 v[20:23], v[68:71], v[196:199], v[20:23]
    ds_read_b64_tr_b16 v[92:93], v14 offset:57344
    ds_read_b64_tr_b16 v[94:95], v14 offset:61440
G_63:
    s_cbranch_execz G_65
    v_cvt_pk_bf16_f32 v229, v234, v235
    v_exp_f32 v238, v238
    v_mfma_f32_16x16x32_bf16 v[100:103], v[104:107], v[196:199], v[100:103]
    v_exp_f32 v239, v239
    v_cvt_pk_bf16_f32 v230, v236, v237
    v_cvt_pk_bf16_f32 v231, v238, v239
    v_mfma_f32_16x16x32_bf16 v[24:27], v[72:75], v[196:199], v[24:27]
    ds_read_b64_tr_b16 v[96:97], v15 offset:57344
    ds_read_b64_tr_b16 v[98:99], v15 offset:61440
    s_waitcnt lgkmcnt(4)
    v_cmp_ne_u32 vcc, 0, v3
    v_mfma_f32_16x16x32_bf16 v[28:31], v[76:79], v[196:199], v[28:31]
    s_cbranch_vccnz C_59
R_60:
    v_add_u32 v8, 65536, v8
    v_add_u32 v9, 65536, v9
    v_add_u32 v10, 65536, v10
    v_add_u32 v11, 65536, v11
    v_add_u32 v12, 65536, v12
    v_add_u32 v13, 65536, v13
    v_add_u32 v14, 65536, v14
    v_add_u32 v15, 65536, v15
    ds_read_b64_tr_b16 v[68:69], v8 offset:0
    ds_read_b64_tr_b16 v[70:71], v8 offset:4096
    v_mfma_f32_16x16x32_bf16 v[32:35], v[80:83], v[196:199], v[32:35]
    ds_read_b64_tr_b16 v[72:73], v9 offset:0
    ds_read_b64_tr_b16 v[74:75], v9 offset:4096
    v_exp_f32 v240, v240
    v_mfma_f32_16x16x32_bf16 v[36:39], v[84:87], v[196:199], v[36:39]
    ds_read_b64_tr_b16 v[76:77], v10 offset:0
    ds_read_b64_tr_b16 v[78:79], v10 offset:4096
    v_exp_f32 v241, v241
    v_mfma_f32_16x16x32_bf16 v[40:43], v[88:91], v[196:199], v[40:43]
    ds_read_b64_tr_b16 v[80:81], v11 offset:0
    ds_read_b64_tr_b16 v[82:83], v11 offset:4096
    v_exp_f32 v242, v242
    s_waitcnt lgkmcnt(8)
G_64:
    s_cbranch_execz G_66
    v_mfma_f32_16x16x32_bf16 v[44:47], v[92:95], v[196:199], v[44:47]
    ds_read_b64_tr_b16 v[84:85], v12 offset:0
    ds_read_b64_tr_b16 v[86:87], v12 offset:4096
    v_exp_f32 v243, v243
    v_mfma_f32_16x16x32_bf16 v[48:51], v[96:99], v[196:199], v[48:51]
    ds_read_b64_tr_b16 v[88:89], v13 offset:0
    ds_read_b64_tr_b16 v[90:91], v13 offset:4096
    buffer_load_dword off, s[72:75], 0 offset:128 lds
    s_waitcnt lgkmcnt(8)
    v_mfma_f32_16x16x32_bf16 v[20:23], v[68:71], v[208:211], v[20:23]
    ds_read_b64_tr_b16 v[92:93], v14 offset:0
    ds_read_b64_tr_b16 v[94:95], v14 offset:4096
    v_cvt_pk_bf16_f32 v240, v240, v241
    v_mfma_f32_16x16x32_bf16 v[100:103], v[104:107], v[208:211], v[100:103]
    v_exp_f32 v244, v244
    v_exp_f32 v245, v245
    v_cvt_pk_bf16_f32 v241, v242, v243
    v_mfma_f32_16x16x32_bf16 v[24:27], v[72:75], v[208:211], v[24:27]
    ds_read_b64_tr_b16 v[96:97], v15 offset:0
    ds_read_b64_tr_b16 v[98:99], v15 offset:4096
    v_exp_f32 v246, v246
    s_waitcnt lgkmcnt(8)
    v_mfma_f32_16x16x32_bf16 v[28:31], v[76:79], v[208:211], v[28:31]
    ds_read_b64_tr_b16 v[68:69], v8 offset:8192
    ds_read_b64_tr_b16 v[70:71], v8 offset:12288
    v_exp_f32 v247, v247
    v_mfma_f32_16x16x32_bf16 v[32:35], v[80:83], v[208:211], v[32:35]
    ds_read_b64_tr_b16 v[72:73], v9 offset:8192
    ds_read_b64_tr_b16 v[74:75], v9 offset:12288
    v_cvt_pk_bf16_f32 v242, v244, v245
    s_waitcnt lgkmcnt(8)
    v_mfma_f32_16x16x32_bf16 v[36:39], v[84:87], v[208:211], v[36:39]
    ds_read_b64_tr_b16 v[76:77], v10 offset:8192
    ds_read_b64_tr_b16 v[78:79], v10 offset:12288
    v_exp_f32 v248, v248
    v_mfma_f32_16x16x32_bf16 v[40:43], v[88:91], v[208:211], v[40:43]
G_65:
    s_cbranch_execz G_67
    ds_read_b64_tr_b16 v[80:81], v11 offset:8192
    ds_read_b64_tr_b16 v[82:83], v11 offset:12288
    v_exp_f32 v249, v249
    s_waitcnt lgkmcnt(8)
    v_mfma_f32_16x16x32_bf16 v[44:47], v[92:95], v[208:211], v[44:47]
    ds_read_b64_tr_b16 v[84:85], v12 offset:8192
    ds_read_b64_tr_b16 v[86:87], v12 offset:12288
    v_cvt_pk_bf16_f32 v243, v246, v247
    v_mfma_f32_16x16x32_bf16 v[48:51], v[96:99], v[208:211], v[48:51]
    ds_read_b64_tr_b16 v[88:89], v13 offset:8192
    ds_read_b64_tr_b16 v[90:91], v13 offset:12288
    ds_read_b32 v3, v2 offset:2232
    s_waitcnt lgkmcnt(9)
    v_mfma_f32_16x16x32_bf16 v[20:23], v[68:71], v[212:215], v[20:23]
    ds_read_b64_tr_b16 v[92:93], v14 offset:8192
    ds_read_b64_tr_b16 v[94:95], v14 offset:12288
    v_exp_f32 v250, v250
    v_mfma_f32_16x16x32_bf16 v[100:103], v[104:107], v[212:215], v[100:103]
    v_exp_f32 v251, v251
    v_cvt_pk_bf16_f32 v244, v248, v249
    v_exp_f32 v252, v252
    v_mfma_f32_16x16x32_bf16 v[24:27], v[72:75], v[212:215], v[24:27]
    ds_read_b64_tr_b16 v[96:97], v15 offset:8192
    ds_read_b64_tr_b16 v[98:99], v15 offset:12288
    s_waitcnt lgkmcnt(4)
    v_cmp_ne_u32 vcc, 0, v3
    v_mfma_f32_16x16x32_bf16 v[28:31], v[76:79], v[212:215], v[28:31]
    s_cbranch_vccnz C_61
R_62:
    ds_read_b64_tr_b16 v[68:69], v8 offset:16384
    ds_read_b64_tr_b16 v[70:71], v8 offset:20480
    v_mfma_f32_16x16x32_bf16 v[32:35], v[80:83], v[212:215], v[32:35]
    ds_read_b64_tr_b16 v[72:73], v9 offset:16384
    ds_read_b64_tr_b16 v[74:75], v9 offset:20480
    v_exp_f32 v253, v253
    v_cvt_pk_bf16_f32 v245, v250, v251
    v_mfma_f32_16x16x32_bf16 v[36:39], v[84:87], v[212:215], v[36:39]
    ds_read_b64_tr_b16 v[76:77], v10 offset:16384
G_66:
    s_cbranch_execz G_68
    ds_read_b64_tr_b16 v[78:79], v10 offset:20480
    v_exp_f32 v254, v254
    v_mfma_f32_16x16x32_bf16 v[40:43], v[88:91], v[212:215], v[40:43]
    ds_read_b64_tr_b16 v[80:81], v11 offset:16384
    ds_read_b64_tr_b16 v[82:83], v11 offset:20480
    v_exp_f32 v255, v255
    s_waitcnt lgkmcnt(8)
    v_mfma_f32_16x16x32_bf16 v[44:47], v[92:95], v[212:215], v[44:47]
    ds_read_b64_tr_b16 v[84:85], v12 offset:16384
    ds_read_b64_tr_b16 v[86:87], v12 offset:20480
    v_cvt_pk_bf16_f32 v246, v252, v253
    v_mfma_f32_16x16x32_bf16 v[48:51], v[96:99], v[212:215], v[48:51]
    ds_read_b64_tr_b16 v[88:89], v13 offset:16384
    ds_read_b64_tr_b16 v[90:91], v13 offset:20480
    buffer_load_dword off, s[72:75], 0 offset:124 lds
    s_waitcnt lgkmcnt(8)
    v_mfma_f32_16x16x32_bf16 v[20:23], v[68:71], v[224:227], v[20:23]
    ds_read_b64_tr_b16 v[92:93], v14 offset:16384
    ds_read_b64_tr_b16 v[94:95], v14 offset:20480
    v_cvt_pk_bf16_f32 v247, v254, v255
    v_mfma_f32_16x16x32_bf16 v[100:103], v[104:107], v[224:227], v[100:103]
    v_mfma_f32_16x16x32_bf16 v[24:27], v[72:75], v[224:227], v[24:27]
    ds_read_b64_tr_b16 v[96:97], v15 offset:16384
    ds_read_b64_tr_b16 v[98:99], v15 offset:20480
    ds_read_b32 v4, v2 offset:132
    s_waitcnt lgkmcnt(9)
    v_mfma_f32_16x16x32_bf16 v[28:31], v[76:79], v[224:227], v[28:31]
    ds_read_b64_tr_b16 v[68:69], v8 offset:24576
    ds_read_b64_tr_b16 v[70:71], v8 offset:28672
    v_mfma_f32_16x16x32_bf16 v[32:35], v[80:83], v[224:227], v[32:35]
    ds_read_b64_tr_b16 v[72:73], v9 offset:24576
    ds_read_b64_tr_b16 v[74:75], v9 offset:28672
    s_waitcnt lgkmcnt(9)
    v_mfma_f32_16x16x32_bf16 v[36:39], v[84:87], v[224:227], v[36:39]
G_67:
    s_cbranch_execz G_69
    ds_read_b64_tr_b16 v[76:77], v10 offset:24576
    ds_read_b64_tr_b16 v[78:79], v10 offset:28672
    v_mfma_f32_16x16x32_bf16 v[40:43], v[88:91], v[224:227], v[40:43]
    ds_read_b64_tr_b16 v[80:81], v11 offset:24576
    ds_read_b64_tr_b16 v[82:83], v11 offset:28672
    s_waitcnt lgkmcnt(8)
    v_cmp_ne_u32 vcc, 0, v4
    s_cbranch_vccnz C_63
R_64:
    v_mfma_f32_16x16x32_bf16 v[44:47], v[92:95], v[224:227], v[44:47]
    ds_read_b64_tr_b16 v[84:85], v12 offset:24576
    ds_read_b64_tr_b16 v[86:87], v12 offset:28672
    v_mfma_f32_16x16x32_bf16 v[48:51], v[96:99], v[224:227], v[48:51]
    ds_read_b64_tr_b16 v[88:89], v13 offset:24576
    ds_read_b64_tr_b16 v[90:91], v13 offset:28672
    ds_read_b32 v3, v2 offset:2228
    s_waitcnt lgkmcnt(9)
    v_mfma_f32_16x16x32_bf16 v[20:23], v[68:71], v[228:231], v[20:23]
    ds_read_b64_tr_b16 v[92:93], v14 offset:24576
    ds_read_b64_tr_b16 v[94:95], v14 offset:28672
    v_mfma_f32_16x16x32_bf16 v[100:103], v[104:107], v[228:231], v[100:103]
    v_mfma_f32_16x16x32_bf16 v[24:27], v[72:75], v[228:231], v[24:27]
    ds_read_b64_tr_b16 v[96:97], v15 offset:24576
    ds_read_b64_tr_b16 v[98:99], v15 offset:28672
    s_waitcnt lgkmcnt(4)
    v_cmp_ne_u32 vcc, 0, v3
    v_mfma_f32_16x16x32_bf16 v[28:31], v[76:79], v[228:231], v[28:31]
    s_cbranch_vccnz C_65
R_66:
    ds_read_b64_tr_b16 v[68:69], v8 offset:32768
    ds_read_b64_tr_b16 v[70:71], v8 offset:36864
    v_mfma_f32_16x16x32_bf16 v[32:35], v[80:83], v[228:231], v[32:35]
    ds_read_b64_tr_b16 v[72:73], v9 offset:32768
    ds_read_b64_tr_b16 v[74:75], v9 offset:36864
    v_mfma_f32_16x16x32_bf16 v[36:39], v[84:87], v[228:231], v[36:39]
    ds_read_b64_tr_b16 v[76:77], v10 offset:32768
    ds_read_b64_tr_b16 v[78:79], v10 offset:36864
G_68:
    s_cbranch_execz G_70
    v_mfma_f32_16x16x32_bf16 v[40:43], v[88:91], v[228:231], v[40:43]
    ds_read_b64_tr_b16 v[80:81], v11 offset:32768
    ds_read_b64_tr_b16 v[82:83], v11 offset:36864
    s_waitcnt lgkmcnt(8)
    v_mfma_f32_16x16x32_bf16 v[44:47], v[92:95], v[228:231], v[44:47]
    ds_read_b64_tr_b16 v[84:85], v12 offset:32768
    ds_read_b64_tr_b16 v[86:87], v12 offset:36864
    v_mfma_f32_16x16x32_bf16 v[48:51], v[96:99], v[228:231], v[48:51]
    ds_read_b64_tr_b16 v[88:89], v13 offset:32768
    ds_read_b64_tr_b16 v[90:91], v13 offset:36864
    buffer_load_dword off, s[72:75], 0 offset:120 lds
    s_waitcnt lgkmcnt(8)
    v_mfma_f32_16x16x32_bf16 v[20:23], v[68:71], v[240:243], v[20:23]
    ds_read_b64_tr_b16 v[92:93], v14 offset:32768
    ds_read_b64_tr_b16 v[94:95], v14 offset:36864
    v_mfma_f32_16x16x32_bf16 v[100:103], v[104:107], v[240:243], v[100:103]
    v_mfma_f32_16x16x32_bf16 v[24:27], v[72:75], v[240:243], v[24:27]
    ds_read_b64_tr_b16 v[96:97], v15 offset:32768
    ds_read_b64_tr_b16 v[98:99], v15 offset:36864
    s_waitcnt lgkmcnt(8)
    v_mfma_f32_16x16x32_bf16 v[28:31], v[76:79], v[240:243], v[28:31]
    ds_read_b64_tr_b16 v[68:69], v8 offset:40960
    ds_read_b64_tr_b16 v[70:71], v8 offset:45056
    v_mfma_f32_16x16x32_bf16 v[32:35], v[80:83], v[240:243], v[32:35]
    ds_read_b64_tr_b16 v[72:73], v9 offset:40960
    ds_read_b64_tr_b16 v[74:75], v9 offset:45056
    s_waitcnt lgkmcnt(8)
    v_mfma_f32_16x16x32_bf16 v[36:39], v[84:87], v[240:243], v[36:39]
    ds_read_b64_tr_b16 v[76:77], v10 offset:40960
    ds_read_b64_tr_b16 v[78:79], v10 offset:45056
    v_mfma_f32_16x16x32_bf16 v[40:43], v[88:91], v[240:243], v[40:43]
    ds_read_b64_tr_b16 v[80:81], v11 offset:40960
    ds_read_b64_tr_b16 v[82:83], v11 offset:45056
    s_waitcnt lgkmcnt(8)
G_69:
    s_cbranch_execz G_71
    v_mfma_f32_16x16x32_bf16 v[44:47], v[92:95], v[240:243], v[44:47]
    ds_read_b64_tr_b16 v[84:85], v12 offset:40960
    ds_read_b64_tr_b16 v[86:87], v12 offset:45056
    v_mfma_f32_16x16x32_bf16 v[48:51], v[96:99], v[240:243], v[48:51]
    ds_read_b64_tr_b16 v[88:89], v13 offset:40960
    ds_read_b64_tr_b16 v[90:91], v13 offset:45056
    s_waitcnt lgkmcnt(8)
    v_mfma_f32_16x16x32_bf16 v[20:23], v[68:71], v[244:247], v[20:23]
    ds_read_b64_tr_b16 v[92:93], v14 offset:40960
    ds_read_b64_tr_b16 v[94:95], v14 offset:45056
    v_mfma_f32_16x16x32_bf16 v[100:103], v[104:107], v[244:247], v[100:103]
    v_mfma_f32_16x16x32_bf16 v[24:27], v[72:75], v[244:247], v[24:27]
    ds_read_b64_tr_b16 v[96:97], v15 offset:40960
    ds_read_b64_tr_b16 v[98:99], v15 offset:45056
    s_waitcnt lgkmcnt(8)
    v_mfma_f32_16x16x32_bf16 v[28:31], v[76:79], v[244:247], v[28:31]
    v_mfma_f32_16x16x32_bf16 v[32:35], v[80:83], v[244:247], v[32:35]
    s_waitcnt lgkmcnt(4)
    v_mfma_f32_16x16x32_bf16 v[36:39], v[84:87], v[244:247], v[36:39]
    v_mfma_f32_16x16x32_bf16 v[40:43], v[88:91], v[244:247], v[40:43]
    v_rcp_f32 v16, v100
    ds_read_b32 v3, v2 offset:2224
    s_waitcnt lgkmcnt(1)
    v_mfma_f32_16x16x32_bf16 v[44:47], v[92:95], v[244:247], v[44:47]
    v_mfma_f32_16x16x32_bf16 v[48:51], v[96:99], v[244:247], v[48:51]
    buffer_load_dword off, s[72:75], 0 offset:116 lds
    v_mul_f32 v20, v20, v16
    v_mul_f32 v21, v21, v16
    v_mul_f32 v22, v22, v16
    v_mul_f32 v23, v23, v16
    v_mul_f32 v24, v24, v16
    v_mul_f32 v25, v25, v16
    v_mul_f32 v26, v26, v16
    v_mul_f32 v27, v27, v16
    v_cvt_pk_bf16_f32 v52, v20, v21
    v_cvt_pk_bf16_f32 v53, v22, v23
    v_cvt_pk_bf16_f32 v54, v24, v25
    v_cvt_pk_bf16_f32 v55, v26, v27
G_70:
    s_cbranch_execz G_72
    buffer_store_dwordx4 v[52:55], v117, s[40:43], s26 offen offset:0 sc1
    v_mul_f32 v28, v28, v16
    v_mul_f32 v29, v29, v16
    v_mul_f32 v30, v30, v16
    v_mul_f32 v31, v31, v16
    v_mul_f32 v32, v32, v16
    v_mul_f32 v33, v33, v16
    v_mul_f32 v34, v34, v16
    v_mul_f32 v35, v35, v16
    v_cvt_pk_bf16_f32 v56, v28, v29
    v_cvt_pk_bf16_f32 v57, v30, v31
    v_cvt_pk_bf16_f32 v58, v32, v33
    v_cvt_pk_bf16_f32 v59, v34, v35
    buffer_store_dwordx4 v[56:59], v117, s[40:43], s26 offen offset:2048 sc1
    v_mul_f32 v36, v36, v16
    v_mul_f32 v37, v37, v16
    v_mul_f32 v38, v38, v16
    v_mul_f32 v39, v39, v16
    v_mul_f32 v40, v40, v16
    v_mul_f32 v41, v41, v16
    v_mul_f32 v42, v42, v16
    v_mul_f32 v43, v43, v16
    v_cvt_pk_bf16_f32 v60, v36, v37
    v_cvt_pk_bf16_f32 v61, v38, v39
    v_cvt_pk_bf16_f32 v62, v40, v41
    v_cvt_pk_bf16_f32 v63, v42, v43
    buffer_store_dwordx4 v[60:63], v117, s[40:43], s27 offen offset:0 sc1
    v_mul_f32 v44, v44, v16
    v_mul_f32 v45, v45, v16
    v_mul_f32 v46, v46, v16
    v_mul_f32 v47, v47, v16
    v_mul_f32 v48, v48, v16
    v_mul_f32 v49, v49, v16
    v_mul_f32 v50, v50, v16
    v_mul_f32 v51, v51, v16
    v_cvt_pk_bf16_f32 v64, v44, v45
    v_cvt_pk_bf16_f32 v65, v46, v47
    v_cvt_pk_bf16_f32 v66, v48, v49
    v_cvt_pk_bf16_f32 v67, v50, v51
    buffer_store_dwordx4 v[64:67], v117, s[40:43], s27 offen offset:2048 sc1
    ds_write_b128 v117, v[52:55] offset:0
    ds_write_b128 v117, v[56:59] offset:2048
    ds_write_b128 v117, v[60:63] offset:4096
    ds_write_b128 v117, v[64:67] offset:6144
G_71:
    s_cbranch_execz G_73
    v_mov_b32 v5, 1
    ds_write_b32 v1, v5 offset:4224
    s_waitcnt lgkmcnt(5)
    v_cmp_ne_u32 vcc, 0, v3
    s_cbranch_vccnz C_67
R_68:
    v_add_u32 v123, 65536, v123
    ds_read_b64_tr_b16 v[128:129], v123 offset:49152
    ds_read_b64_tr_b16 v[130:131], v123 offset:53248
    ds_read_b64_tr_b16 v[132:133], v123 offset:51200
    ds_read_b64_tr_b16 v[134:135], v123 offset:55296
    ds_read_b64_tr_b16 v[136:137], v123 offset:57344
    ds_read_b64_tr_b16 v[138:139], v123 offset:61440
    ds_read_b64_tr_b16 v[140:141], v123 offset:59392
    ds_read_b64_tr_b16 v[142:143], v123 offset:63488
    ds_read_b32 v3, v2 offset:2220
    ds_read_b32 v4, v2 offset:4224
    s_waitcnt lgkmcnt(0)
    v_cmp_gt_u32 vcc, 1, v4
    s_cbranch_vccnz C_69
R_70:
    ds_read_b128 v[20:23], v119 offset:0
    ds_read_b128 v[24:27], v119 offset:1024
    ds_read_b128 v[28:31], v119 offset:2048
    ds_read_b128 v[32:35], v119 offset:3072
    ds_read_b128 v[36:39], v120 offset:0
    ds_read_b128 v[40:43], v120 offset:1024
    ds_read_b128 v[44:47], v120 offset:2048
    ds_read_b128 v[48:51], v120 offset:3072
    ds_read_b128 v[68:71], v121 offset:0
    ds_read_b128 v[72:75], v121 offset:1024
    ds_read_b128 v[76:79], v121 offset:2048
    ds_read_b128 v[80:83], v121 offset:3072
    ds_read_b128 v[84:87], v122 offset:0
    ds_read_b128 v[88:91], v122 offset:1024
    ds_read_b128 v[92:95], v122 offset:2048
    ds_read_b128 v[96:99], v122 offset:3072
G_72:
    s_cbranch_execz G_74
    s_waitcnt lgkmcnt(15)
    v_mfma_f32_32x32x16_bf16 v[52:67], v[128:131], v[20:23], 0
    v_cmp_ne_u32 vcc, 0, v3
    s_cbranch_vccnz C_71
R_72:
    v_add_u32 v123, 65536, v123
    ds_read_b64_tr_b16 v[144:145], v123 offset:0
    ds_read_b64_tr_b16 v[146:147], v123 offset:4096
    s_waitcnt lgkmcnt(15)
    v_mfma_f32_32x32x16_bf16 v[52:67], v[132:135], v[24:27], v[52:67]
    ds_read_b64_tr_b16 v[148:149], v123 offset:2048
    ds_read_b64_tr_b16 v[150:151], v123 offset:6144
    ds_read_b32 v3, v2 offset:2216
    v_mfma_f32_32x32x16_bf16 v[52:67], v[136:139], v[28:31], v[52:67]
    ds_read_b64_tr_b16 v[152:153], v123 offset:8192
    ds_read_b64_tr_b16 v[154:155], v123 offset:12288
    s_waitcnt lgkmcnt(7)
    buffer_load_dword off, s[72:75], 0 offset:112 lds
    v_mfma_f32_32x32x16_bf16 v[52:67], v[140:143], v[32:35], v[52:67]
    ds_read_b64_tr_b16 v[156:157], v123 offset:10240
    ds_read_b64_tr_b16 v[158:159], v123 offset:14336
    s_waitcnt vmcnt(1)
    s_mov_b64 exec, 1
    buffer_store_dword v118, off, s[40:43], s28 sc1
    s_mov_b64 exec, -1
    s_waitcnt lgkmcnt(4)
    v_cmp_ne_u32 vcc, 0, v3
    v_mfma_f32_32x32x16_bf16 v[52:67], v[144:147], v[36:39], v[52:67]
    s_cbranch_vccnz C_73
R_74:
    v_subrev_u32 v123, 131072, v123
    ds_read_b64_tr_b16 v[160:161], v123 offset:0
    ds_read_b64_tr_b16 v[162:163], v123 offset:4096
    v_mfma_f32_32x32x16_bf16 v[52:67], v[148:151], v[40:43], v[52:67]
    ds_read_b64_tr_b16 v[164:165], v123 offset:2048
    ds_read_b64_tr_b16 v[166:167], v123 offset:6144
    ds_read_b32 v3, v2 offset:2212
    s_waitcnt lgkmcnt(7)
    v_mfma_f32_32x32x16_bf16 v[52:67], v[152:155], v[44:47], v[52:67]
G_73:
    s_cbranch_execz G_75
    ds_read_b64_tr_b16 v[168:169], v123 offset:8192
    ds_read_b64_tr_b16 v[170:171], v123 offset:12288
    s_waitcnt lgkmcnt(7)
    v_mfma_f32_32x32x16_bf16 v[52:67], v[156:159], v[48:51], v[52:67]
    ds_read_b64_tr_b16 v[172:173], v123 offset:10240
    ds_read_b64_tr_b16 v[174:175], v123 offset:14336
    s_waitcnt lgkmcnt(4)
    v_cmp_ne_u32 vcc, 0, v3
    v_mfma_f32_32x32x16_bf16 v[52:67], v[160:163], v[68:71], v[52:67]
    s_cbranch_vccnz C_75
R_76:
    ds_read_b64_tr_b16 v[176:177], v123 offset:16384
    ds_read_b64_tr_b16 v[178:179], v123 offset:20480
    v_mfma_f32_32x32x16_bf16 v[52:67], v[164:167], v[72:75], v[52:67]
    ds_read_b64_tr_b16 v[180:181], v123 offset:18432
    ds_read_b64_tr_b16 v[182:183], v123 offset:22528
    ds_read_b32 v3, v2 offset:2204
    s_waitcnt lgkmcnt(7)
    v_mfma_f32_32x32x16_bf16 v[52:67], v[168:171], v[76:79], v[52:67]
    ds_read_b64_tr_b16 v[184:185], v123 offset:24576
    ds_read_b64_tr_b16 v[186:187], v123 offset:28672
    s_waitcnt lgkmcnt(7)
    v_mfma_f32_32x32x16_bf16 v[52:67], v[172:175], v[80:83], v[52:67]
    ds_read_b64_tr_b16 v[188:189], v123 offset:26624
    ds_read_b64_tr_b16 v[190:191], v123 offset:30720
    s_waitcnt lgkmcnt(4)
    v_cmp_ne_u32 vcc, 0, v3
    v_mfma_f32_32x32x16_bf16 v[52:67], v[176:179], v[84:87], v[52:67]
    s_cbranch_vccnz C_77
R_78:
    ds_read_b64_tr_b16 v[192:193], v123 offset:49152
    ds_read_b64_tr_b16 v[194:195], v123 offset:53248
    v_mfma_f32_32x32x16_bf16 v[52:67], v[180:183], v[88:91], v[52:67]
    ds_read_b64_tr_b16 v[196:197], v123 offset:51200
    ds_read_b64_tr_b16 v[198:199], v123 offset:55296
    ds_read_b32 v3, v2 offset:2200
    s_waitcnt lgkmcnt(7)
    v_mfma_f32_32x32x16_bf16 v[52:67], v[184:187], v[92:95], v[52:67]
    ds_read_b64_tr_b16 v[200:201], v123 offset:57344
G_74:
    s_cbranch_execz G_76
    ds_read_b64_tr_b16 v[202:203], v123 offset:61440
    s_waitcnt lgkmcnt(7)
    v_mfma_f32_32x32x16_bf16 v[52:67], v[188:191], v[96:99], v[52:67]
    ds_read_b64_tr_b16 v[204:205], v123 offset:59392
    ds_read_b64_tr_b16 v[206:207], v123 offset:63488
    s_waitcnt lgkmcnt(4)
    v_cmp_ne_u32 vcc, 0, v3
    v_mfma_f32_32x32x16_bf16 v[100:115], v[192:195], v[20:23], 0
    s_cbranch_vccnz C_79
R_80:
    v_add_u32 v123, 65536, v123
    ds_read_b64_tr_b16 v[208:209], v123 offset:0
    ds_read_b64_tr_b16 v[210:211], v123 offset:4096
    v_mfma_f32_32x32x16_bf16 v[100:115], v[196:199], v[24:27], v[100:115]
    ds_read_b64_tr_b16 v[212:213], v123 offset:2048
    ds_read_b64_tr_b16 v[214:215], v123 offset:6144
    ds_read_b32 v3, v2 offset:2196
    s_waitcnt lgkmcnt(7)
    v_mfma_f32_32x32x16_bf16 v[100:115], v[200:203], v[28:31], v[100:115]
    ds_read_b64_tr_b16 v[216:217], v123 offset:8192
    ds_read_b64_tr_b16 v[218:219], v123 offset:12288
    v_cvt_pk_bf16_f32 v8, v52, v53
    v_cvt_pk_bf16_f32 v9, v54, v55
    s_waitcnt lgkmcnt(7)
    v_mfma_f32_32x32x16_bf16 v[100:115], v[204:207], v[32:35], v[100:115]
    ds_read_b64_tr_b16 v[220:221], v123 offset:10240
    ds_read_b64_tr_b16 v[222:223], v123 offset:14336
    s_waitcnt lgkmcnt(4)
    v_cmp_ne_u32 vcc, 0, v3
    v_mfma_f32_32x32x16_bf16 v[100:115], v[208:211], v[36:39], v[100:115]
    s_cbranch_vccnz C_81
R_82:
    ds_read_b64_tr_b16 v[224:225], v123 offset:16384
    ds_read_b64_tr_b16 v[226:227], v123 offset:20480
    v_mov_b32 v17, 153792
    v_mfma_f32_32x32x16_bf16 v[100:115], v[212:215], v[40:43], v[100:115]
    ds_read_b64_tr_b16 v[228:229], v123 offset:18432
    ds_read_b64_tr_b16 v[230:231], v123 offset:22528
G_75:
    s_cbranch_execz G_77
    ds_read_b32 v3, v2 offset:2192
    s_waitcnt lgkmcnt(7)
    v_mfma_f32_32x32x16_bf16 v[100:115], v[216:219], v[44:47], v[100:115]
    ds_read_b64_tr_b16 v[232:233], v123 offset:24576
    ds_read_b64_tr_b16 v[234:235], v123 offset:28672
    v_cvt_pk_bf16_f32 v10, v56, v57
    v_cvt_pk_bf16_f32 v11, v58, v59
    s_waitcnt lgkmcnt(7)
    v_mfma_f32_32x32x16_bf16 v[100:115], v[220:223], v[48:51], v[100:115]
    ds_read_b64_tr_b16 v[236:237], v123 offset:26624
    ds_read_b64_tr_b16 v[238:239], v123 offset:30720
    s_waitcnt lgkmcnt(4)
    v_cmp_ne_u32 vcc, 0, v3
    v_mfma_f32_32x32x16_bf16 v[100:115], v[224:227], v[68:71], v[100:115]
    s_cbranch_vccnz C_83
R_84:
    ds_read_b64_tr_b16 v[240:241], v123 offset:32768
    ds_read_b64_tr_b16 v[242:243], v123 offset:36864
    v_mfma_f32_32x32x16_bf16 v[100:115], v[228:231], v[72:75], v[100:115]
    ds_read_b64_tr_b16 v[244:245], v123 offset:34816
    ds_read_b64_tr_b16 v[246:247], v123 offset:38912
    v_cvt_pk_bf16_f32 v12, v60, v61
    v_cvt_pk_bf16_f32 v13, v62, v63
    s_waitcnt lgkmcnt(6)
    v_mfma_f32_32x32x16_bf16 v[100:115], v[232:235], v[76:79], v[100:115]
    ds_read_b64_tr_b16 v[248:249], v123 offset:40960
    ds_read_b64_tr_b16 v[250:251], v123 offset:45056
    v_cvt_pk_bf16_f32 v14, v64, v65
    s_waitcnt lgkmcnt(6)
    v_mfma_f32_32x32x16_bf16 v[100:115], v[236:239], v[80:83], v[100:115]
    ds_read_b64_tr_b16 v[252:253], v123 offset:43008
    ds_read_b64_tr_b16 v[254:255], v123 offset:47104
    v_cvt_pk_bf16_f32 v15, v66, v67
    s_waitcnt lgkmcnt(6)
    v_mfma_f32_32x32x16_bf16 v[100:115], v[240:243], v[84:87], v[100:115]
    s_waitcnt lgkmcnt(4)
    v_mfma_f32_32x32x16_bf16 v[100:115], v[244:247], v[88:91], v[100:115]
G_76:
    s_cbranch_execz G_78
    s_waitcnt lgkmcnt(2)
    v_mfma_f32_32x32x16_bf16 v[100:115], v[248:251], v[92:95], v[100:115]
    s_waitcnt lgkmcnt(0)
    v_mfma_f32_32x32x16_bf16 v[100:115], v[252:255], v[96:99], v[100:115]
    s_nop 11
    v_cvt_pk_bf16_f32 v100, v100, v101
    v_cvt_pk_bf16_f32 v101, v102, v103
    v_cvt_pk_bf16_f32 v102, v104, v105
    v_cvt_pk_bf16_f32 v103, v106, v107
    v_cvt_pk_bf16_f32 v104, v108, v109
    v_cvt_pk_bf16_f32 v105, v110, v111
    v_cvt_pk_bf16_f32 v106, v112, v113
    v_cvt_pk_bf16_f32 v107, v114, v115
L_p2w:
    ds_read_b32 v3, v17 offset:256
    s_sub_u32 s68, s68, 1
    s_cbranch_scc1 L_cend
    s_waitcnt lgkmcnt(0)
    v_cmp_ne_u32 vcc, 0, v3
    s_cbranch_vccnz L_p2w
    ds_read_b128 v[20:23], v119 offset:0
    ds_read_b128 v[24:27], v119 offset:1024
    ds_read_b128 v[28:31], v119 offset:2048
    ds_read_b128 v[32:35], v119 offset:3072
    ds_read_b128 v[36:39], v120 offset:0
    ds_read_b128 v[40:43], v120 offset:1024
    ds_read_b128 v[44:47], v120 offset:2048
    ds_read_b128 v[48:51], v120 offset:3072
    ds_read_b128 v[68:71], v121 offset:0
    ds_read_b128 v[72:75], v121 offset:1024
    ds_read_b128 v[76:79], v121 offset:2048
    ds_read_b128 v[80:83], v121 offset:3072
    ds_read_b128 v[84:87], v122 offset:0
    ds_read_b128 v[88:91], v122 offset:1024
    ds_read_b128 v[92:95], v122 offset:2048
    ds_read_b128 v[96:99], v122 offset:3072
G_77:
    s_cbranch_execz G_79
    buffer_store_dwordx4 v[8:11], v116, s[40:43], s20 offen offset:0 sc1
    buffer_store_dwordx4 v[12:15], v116, s[40:43], s20 offen offset:1024 sc1
    buffer_store_dwordx4 v[100:103], v116, s[40:43], s21 offen offset:0 sc1
    buffer_store_dwordx4 v[104:107], v116, s[40:43], s21 offen offset:1024 sc1
    s_waitcnt lgkmcnt(15)
    v_mfma_f32_32x32x16_bf16 v[52:67], v[128:131], v[20:23], 0
    s_waitcnt lgkmcnt(14)
    v_mfma_f32_32x32x16_bf16 v[52:67], v[132:135], v[24:27], v[52:67]
    s_waitcnt lgkmcnt(13)
    v_mfma_f32_32x32x16_bf16 v[52:67], v[136:139], v[28:31], v[52:67]
    s_waitcnt lgkmcnt(12)
    v_mfma_f32_32x32x16_bf16 v[52:67], v[140:143], v[32:35], v[52:67]
    s_waitcnt lgkmcnt(11)
    v_mfma_f32_32x32x16_bf16 v[52:67], v[144:147], v[36:39], v[52:67]
    s_waitcnt lgkmcnt(10)
    v_mfma_f32_32x32x16_bf16 v[52:67], v[148:151], v[40:43], v[52:67]
    s_waitcnt lgkmcnt(9)
    v_mfma_f32_32x32x16_bf16 v[52:67], v[152:155], v[44:47], v[52:67]
    s_waitcnt lgkmcnt(8)
    v_mfma_f32_32x32x16_bf16 v[52:67], v[156:159], v[48:51], v[52:67]
    s_waitcnt lgkmcnt(7)
    v_mfma_f32_32x32x16_bf16 v[52:67], v[160:163], v[68:71], v[52:67]
    s_waitcnt lgkmcnt(6)
    v_mfma_f32_32x32x16_bf16 v[52:67], v[164:167], v[72:75], v[52:67]
    s_waitcnt lgkmcnt(5)
    v_mfma_f32_32x32x16_bf16 v[52:67], v[168:171], v[76:79], v[52:67]
    s_waitcnt lgkmcnt(4)
    v_mfma_f32_32x32x16_bf16 v[52:67], v[172:175], v[80:83], v[52:67]
    s_waitcnt lgkmcnt(3)
    v_mfma_f32_32x32x16_bf16 v[52:67], v[176:179], v[84:87], v[52:67]
    s_waitcnt lgkmcnt(2)
    v_mfma_f32_32x32x16_bf16 v[52:67], v[180:183], v[88:91], v[52:67]
    s_waitcnt lgkmcnt(1)
    v_mfma_f32_32x32x16_bf16 v[52:67], v[184:187], v[92:95], v[52:67]
    s_waitcnt lgkmcnt(0)
    v_mfma_f32_32x32x16_bf16 v[52:67], v[188:191], v[96:99], v[52:67]
    v_mfma_f32_32x32x16_bf16 v[128:143], v[192:195], v[20:23], 0
    v_mfma_f32_32x32x16_bf16 v[128:143], v[196:199], v[24:27], v[128:143]
    v_mfma_f32_32x32x16_bf16 v[128:143], v[200:203], v[28:31], v[128:143]
    s_nop 8
G_78:
    s_cbranch_execz G_80
    v_cvt_pk_bf16_f32 v52, v52, v53
    v_cvt_pk_bf16_f32 v53, v54, v55
    v_mfma_f32_32x32x16_bf16 v[128:143], v[204:207], v[32:35], v[128:143]
    v_cvt_pk_bf16_f32 v54, v56, v57
    v_cvt_pk_bf16_f32 v55, v58, v59
    v_mfma_f32_32x32x16_bf16 v[128:143], v[208:211], v[36:39], v[128:143]
    v_mfma_f32_32x32x16_bf16 v[128:143], v[212:215], v[40:43], v[128:143]
    buffer_store_dwordx4 v[52:55], v116, s[40:43], s22 offen offset:0 sc1
    v_mfma_f32_32x32x16_bf16 v[128:143], v[216:219], v[44:47], v[128:143]
    v_cvt_pk_bf16_f32 v56, v60, v61
    v_cvt_pk_bf16_f32 v57, v62, v63
    v_mfma_f32_32x32x16_bf16 v[128:143], v[220:223], v[48:51], v[128:143]
    v_cvt_pk_bf16_f32 v58, v64, v65
    v_cvt_pk_bf16_f32 v59, v66, v67
    v_mfma_f32_32x32x16_bf16 v[128:143], v[224:227], v[68:71], v[128:143]
    v_mfma_f32_32x32x16_bf16 v[128:143], v[228:231], v[72:75], v[128:143]
    buffer_store_dwordx4 v[56:59], v116, s[40:43], s22 offen offset:1024 sc1
    v_mfma_f32_32x32x16_bf16 v[128:143], v[232:235], v[76:79], v[128:143]
    v_mfma_f32_32x32x16_bf16 v[128:143], v[236:239], v[80:83], v[128:143]
    v_mfma_f32_32x32x16_bf16 v[128:143], v[240:243], v[84:87], v[128:143]
    v_mov_b32 v168, 0
    v_mov_b32 v169, 0
    v_mov_b32 v170, 0
    v_mov_b32 v171, 0
    v_mfma_f32_32x32x16_bf16 v[128:143], v[244:247], v[88:91], v[128:143]
    v_mov_b32 v172, 0
    v_mov_b32 v173, 0
    v_mov_b32 v174, 0
    v_mov_b32 v175, 0
    v_mfma_f32_32x32x16_bf16 v[128:143], v[248:251], v[92:95], v[128:143]
    v_mfma_f32_32x32x16_bf16 v[128:143], v[252:255], v[96:99], v[128:143]
    ds_read_b32 v4, v17
    s_nop 10
    v_cvt_pk_bf16_f32 v128, v128, v129
    v_cvt_pk_bf16_f32 v129, v130, v131
    v_cvt_pk_bf16_f32 v130, v132, v133
G_79:
    s_cbranch_execz G_81
    v_cvt_pk_bf16_f32 v131, v134, v135
    buffer_store_dwordx4 v[128:131], v116, s[40:43], s23 offen offset:0 sc1
    v_cvt_pk_bf16_f32 v132, v136, v137
    v_cvt_pk_bf16_f32 v133, v138, v139
    v_cvt_pk_bf16_f32 v134, v140, v141
    v_cvt_pk_bf16_f32 v135, v142, v143
    buffer_store_dwordx4 v[132:135], v116, s[40:43], s23 offen offset:1024 sc1
    s_mov_b32 s37, 0
    s_waitcnt vmcnt(0)
    s_mov_b64 exec, 15
    buffer_store_dword v118, v124, s[40:43], s24 offen sc1
    s_mov_b64 exec, -1
    v_mov_b32 v5, 2
    ds_write_b32 v1, v5 offset:4224
L_r0:
    ds_read_b32 v4, v17
    s_sub_u32 s68, s68, 1
    s_cbranch_scc1 L_cend
    s_waitcnt lgkmcnt(0)
    v_readfirstlane_b32 s38, v4
    s_andn2_b32 s38, s38, s37
    s_cbranch_scc0 L_r0
    s_bitcmp1_b32 s38, 0
    s_cbranch_scc0 RL_85
    buffer_load_dwordx4 v[192:195], v125, s[40:43], s80 offen sc1
RL_85:
    s_bitcmp1_b32 s38, 2
    s_cbranch_scc0 RL_86
    buffer_load_dwordx4 v[196:199], v125, s[40:43], s81 offen sc1
RL_86:
    s_bitcmp1_b32 s38, 4
    s_cbranch_scc0 RL_87
    buffer_load_dwordx4 v[200:203], v125, s[40:43], s82 offen sc1
RL_87:
    s_bitcmp1_b32 s38, 6
    s_cbranch_scc0 RL_88
    buffer_load_dwordx4 v[204:207], v125, s[40:43], s83 offen sc1
RL_88:
    s_bitcmp1_b32 s38, 8
    s_cbranch_scc0 RL_89
    buffer_load_dwordx4 v[208:211], v125, s[40:43], s84 offen sc1
RL_89:
    s_bitcmp1_b32 s38, 10
    s_cbranch_scc0 RL_90
    buffer_load_dwordx4 v[212:215], v125, s[40:43], s85 offen sc1
RL_90:
    s_bitcmp1_b32 s38, 12
    s_cbranch_scc0 RL_91
    buffer_load_dwordx4 v[216:219], v125, s[40:43], s86 offen sc1
RL_91:
    s_bitcmp1_b32 s38, 14
    s_cbranch_scc0 RL_92
    buffer_load_dwordx4 v[220:223], v125, s[40:43], s87 offen sc1
RL_92:
G_80:
    s_cbranch_execz G_82
    s_or_b32 s37, s37, s38
    s_cmp_eq_u32 s37, 0x5555
    s_cbranch_scc0 L_r0
    s_bcnt1_i32_b32 s39, s38
    s_xor_b32 s37, s37, s38
    s_waitcnt vmcnt(3)
    s_cmp_ge_u32 s39, 3
    s_cbranch_scc1 L_r2
    s_waitcnt vmcnt(2)
    s_cmp_ge_u32 s39, 2
    s_cbranch_scc1 L_r2
    s_waitcnt vmcnt(1)
L_r2:
    s_bitcmp1_b32 s37, 0
    s_cbranch_scc0 RA_93
    v_lshlrev_b32 v11, 16, v192
    v_and_b32 v12, 0xffff0000, v192
    v_add_f32 v168, v168, v11
    v_add_f32 v169, v169, v12
    v_lshlrev_b32 v11, 16, v193
    v_and_b32 v12, 0xffff0000, v193
    v_add_f32 v170, v170, v11
    v_add_f32 v171, v171, v12
    v_lshlrev_b32 v11, 16, v194
    v_and_b32 v12, 0xffff0000, v194
    v_add_f32 v172, v172, v11
    v_add_f32 v173, v173, v12
    v_lshlrev_b32 v11, 16, v195
    v_and_b32 v12, 0xffff0000, v195
    v_add_f32 v174, v174, v11
    v_add_f32 v175, v175, v12
RA_93:
    s_bitcmp1_b32 s37, 2
    s_cbranch_scc0 RA_94
    v_lshlrev_b32 v11, 16, v196
    v_and_b32 v12, 0xffff0000, v196
    v_add_f32 v168, v168, v11
    v_add_f32 v169, v169, v12
    v_lshlrev_b32 v11, 16, v197
    v_and_b32 v12, 0xffff0000, v197
    v_add_f32 v170, v170, v11
    v_add_f32 v171, v171, v12
    v_lshlrev_b32 v11, 16, v198
    v_and_b32 v12, 0xffff0000, v198
    v_add_f32 v172, v172, v11
    v_add_f32 v173, v173, v12
    v_lshlrev_b32 v11, 16, v199
    v_and_b32 v12, 0xffff0000, v199
    v_add_f32 v174, v174, v11
    v_add_f32 v175, v175, v12
RA_94:
    s_bitcmp1_b32 s37, 4
    s_cbranch_scc0 RA_95
    v_lshlrev_b32 v11, 16, v200
    v_and_b32 v12, 0xffff0000, v200
    v_add_f32 v168, v168, v11
G_81:
    s_cbranch_execz L_warm_ret
    v_add_f32 v169, v169, v12
    v_lshlrev_b32 v11, 16, v201
    v_and_b32 v12, 0xffff0000, v201
    v_add_f32 v170, v170, v11
    v_add_f32 v171, v171, v12
    v_lshlrev_b32 v11, 16, v202
    v_and_b32 v12, 0xffff0000, v202
    v_add_f32 v172, v172, v11
    v_add_f32 v173, v173, v12
    v_lshlrev_b32 v11, 16, v203
    v_and_b32 v12, 0xffff0000, v203
    v_add_f32 v174, v174, v11
    v_add_f32 v175, v175, v12
RA_95:
    s_bitcmp1_b32 s37, 6
    s_cbranch_scc0 RA_96
    v_lshlrev_b32 v11, 16, v204
    v_and_b32 v12, 0xffff0000, v204
    v_add_f32 v168, v168, v11
    v_add_f32 v169, v169, v12
    v_lshlrev_b32 v11, 16, v205
    v_and_b32 v12, 0xffff0000, v205
    v_add_f32 v170, v170, v11
    v_add_f32 v171, v171, v12
    v_lshlrev_b32 v11, 16, v206
    v_and_b32 v12, 0xffff0000, v206
    v_add_f32 v172, v172, v11
    v_add_f32 v173, v173, v12
    v_lshlrev_b32 v11, 16, v207
    v_and_b32 v12, 0xffff0000, v207
    v_add_f32 v174, v174, v11
    v_add_f32 v175, v175, v12
RA_96:
    s_bitcmp1_b32 s37, 8
    s_cbranch_scc0 RA_97
    v_lshlrev_b32 v11, 16, v208
    v_and_b32 v12, 0xffff0000, v208
    v_add_f32 v168, v168, v11
    v_add_f32 v169, v169, v12
    v_lshlrev_b32 v11, 16, v209
    v_and_b32 v12, 0xffff0000, v209
    v_add_f32 v170, v170, v11
    v_add_f32 v171, v171, v12
    v_lshlrev_b32 v11, 16, v210
    v_and_b32 v12, 0xffff0000, v210
    v_add_f32 v172, v172, v11
    v_add_f32 v173, v173, v12
    v_lshlrev_b32 v11, 16, v211
    v_and_b32 v12, 0xffff0000, v211
    v_add_f32 v174, v174, v11
    v_add_f32 v175, v175, v12
RA_97:
    s_bitcmp1_b32 s37, 10
    s_cbranch_scc0 RA_98
    v_lshlrev_b32 v11, 16, v212
G_82:
    s_cbranch_execz L_warm_ret
    v_and_b32 v12, 0xffff0000, v212
    v_add_f32 v168, v168, v11
    v_add_f32 v169, v169, v12
    v_lshlrev_b32 v11, 16, v213
    v_and_b32 v12, 0xffff0000, v213
    v_add_f32 v170, v170, v11
    v_add_f32 v171, v171, v12
    v_lshlrev_b32 v11, 16, v214
    v_and_b32 v12, 0xffff0000, v214
    v_add_f32 v172, v172, v11
    v_add_f32 v173, v173, v12
    v_lshlrev_b32 v11, 16, v215
    v_and_b32 v12, 0xffff0000, v215
    v_add_f32 v174, v174, v11
    v_add_f32 v175, v175, v12
RA_98:
    s_bitcmp1_b32 s37, 12
    s_cbranch_scc0 RA_99
    v_lshlrev_b32 v11, 16, v216
    v_and_b32 v12, 0xffff0000, v216
    v_add_f32 v168, v168, v11
    v_add_f32 v169, v169, v12
    v_lshlrev_b32 v11, 16, v217
    v_and_b32 v12, 0xffff0000, v217
    v_add_f32 v170, v170, v11
    v_add_f32 v171, v171, v12
    v_lshlrev_b32 v11, 16, v218
    v_and_b32 v12, 0xffff0000, v218
    v_add_f32 v172, v172, v11
    v_add_f32 v173, v173, v12
    v_lshlrev_b32 v11, 16, v219
    v_and_b32 v12, 0xffff0000, v219
    v_add_f32 v174, v174, v11
    v_add_f32 v175, v175, v12
RA_99:
    s_bitcmp1_b32 s37, 14
    s_cbranch_scc0 RA_100
    v_lshlrev_b32 v11, 16, v220
    v_and_b32 v12, 0xffff0000, v220
    v_add_f32 v168, v168, v11
    v_add_f32 v169, v169, v12
    v_lshlrev_b32 v11, 16, v221
    v_and_b32 v12, 0xffff0000, v221
    v_add_f32 v170, v170, v11
    v_add_f32 v171, v171, v12
    v_lshlrev_b32 v11, 16, v222
    v_and_b32 v12, 0xffff0000, v222
    v_add_f32 v172, v172, v11
    v_add_f32 v173, v173, v12
    v_lshlrev_b32 v11, 16, v223
    v_and_b32 v12, 0xffff0000, v223
    v_add_f32 v174, v174, v11
    v_add_f32 v175, v175, v12
RA_100:
G_12:
    s_cbranch_execz G_14
    s_mov_b32 s37, s38
    s_mov_b32 s38, 0
    s_waitcnt vmcnt(0)
    s_cmp_lg_u32 s37, 0
    s_cbranch_scc1 L_r2
    s_nop 0
    v_permlane32_swap_b32 v168, v172
    v_permlane32_swap_b32 v169, v173
    v_permlane32_swap_b32 v170, v174
    v_permlane32_swap_b32 v171, v175
    v_add_f32 v168, v168, v172
    v_add_f32 v169, v169, v173
    v_add_f32 v170, v170, v174
    v_add_f32 v171, v171, v175
    v_cvt_pk_bf16_f32 v12, v168, v169
    v_cvt_pk_bf16_f32 v13, v170, v171
    buffer_store_dwordx2 v[12:13], v126, s[44:47], s33 offen
    s_and_b32 s59, s51, 1
    s_or_b32 s59, s59, s53
    s_or_b32 s59, s59, s49
    s_cbranch_scc1 L_nobump
    s_mov_b64 exec, 1
    buffer_store_dword v118, off, s[40:43], s69 sc1
    s_mov_b64 exec, -1
L_nobump:
L_cend:
    s_endpgm
L_cold:
C_1:
    ds_read_b32 v3, v2 offset:2352
    s_sub_u32 s68, s68, 1
    s_cbranch_scc1 L_main_end
    s_waitcnt lgkmcnt(0)
    v_cmp_ne_u32 vcc, 0, v3
    s_cbranch_vccnz C_1
    s_branch R_2
C_3:
    ds_read_b32 v3, v2 offset:2348
    s_sub_u32 s68, s68, 1
    s_cbranch_scc1 L_main_end
    s_waitcnt lgkmcnt(0)
    v_cmp_ne_u32 vcc, 0, v3
    s_cbranch_vccnz C_3
    s_branch R_4
C_5:
    ds_read_b32 v3, v2 offset:2344
    s_sub_u32 s68, s68, 1
    s_cbranch_scc1 L_main_end
    s_waitcnt lgkmcnt(0)
    v_cmp_ne_u32 vcc, 0, v3
    s_cbranch_vccnz C_5
    s_branch R_6
C_7:
    ds_read_b32 v3, v2 offset:2340
    s_sub_u32 s68, s68, 1
    s_cbranch_scc1 L_main_end
    s_waitcnt lgkmcnt(0)
    v_cmp_ne_u32 vcc, 0, v3
    s_cbranch_vccnz C_7
    s_branch R_8
C_9:
    ds_read_b32 v3, v2 offset:2336
G_13:
    s_cbranch_execz G_15
    s_sub_u32 s68, s68, 1
    s_cbranch_scc1 L_main_end
    s_waitcnt lgkmcnt(0)
    v_cmp_ne_u32 vcc, 0, v3
    s_cbranch_vccnz C_9
    s_branch R_10
C_11:
    ds_read_b32 v3, v2 offset:2332
    s_sub_u32 s68, s68, 1
    s_cbranch_scc1 L_main_end
    s_waitcnt lgkmcnt(0)
    v_cmp_ne_u32 vcc, 0, v3
    s_cbranch_vccnz C_11
    s_branch R_12
C_13:
    ds_read_b32 v3, v2 offset:2328
    s_sub_u32 s68, s68, 1
    s_cbranch_scc1 L_main_end
    s_waitcnt lgkmcnt(0)
    v_cmp_ne_u32 vcc, 0, v3
    s_cbranch_vccnz C_13
    s_branch R_14
C_15:
    ds_read_b32 v3, v2 offset:2324
    s_sub_u32 s68, s68, 1
    s_cbranch_scc1 L_main_end
    s_waitcnt lgkmcnt(0)
    v_cmp_ne_u32 vcc, 0, v3
    s_cbranch_vccnz C_15
    s_branch R_16
C_17:
    ds_read_b32 v3, v2 offset:2320
    s_sub_u32 s68, s68, 1
    s_cbranch_scc1 L_main_end
    s_waitcnt lgkmcnt(0)
    v_cmp_ne_u32 vcc, 0, v3
    s_cbranch_vccnz C_17
    s_branch R_18
C_19:
    ds_read_b32 v3, v2 offset:2316
    s_sub_u32 s68, s68, 1
    s_cbranch_scc1 L_main_end
    s_waitcnt lgkmcnt(0)
    v_cmp_ne_u32 vcc, 0, v3
    s_cbranch_vccnz C_19
    s_branch R_20
C_21:
    ds_read_b32 v3, v2 offset:2312
    s_sub_u32 s68, s68, 1
    s_cbranch_scc1 L_main_end
    s_waitcnt lgkmcnt(0)
    v_cmp_ne_u32 vcc, 0, v3
    s_cbranch_vccnz C_21
    s_branch R_22
C_23:
    ds_read_b32 v3, v2 offset:2308
    s_sub_u32 s68, s68, 1
    s_cbranch_scc1 L_main_end
    s_waitcnt lgkmcnt(0)
    v_cmp_ne_u32 vcc, 0, v3
    s_cbranch_vccnz C_23
    s_branch R_24
C_25:
    ds_read_b32 v3, v2 offset:2304
G_14:
    s_cbranch_execz G_16
    s_sub_u32 s68, s68, 1
    s_cbranch_scc1 L_main_end
    s_waitcnt lgkmcnt(0)
    v_cmp_ne_u32 vcc, 0, v3
    s_cbranch_vccnz C_25
    s_branch R_26
C_27:
    ds_read_b32 v3, v2 offset:2300
    s_sub_u32 s68, s68, 1
    s_cbranch_scc1 L_main_end
    s_waitcnt lgkmcnt(0)
    v_cmp_ne_u32 vcc, 0, v3
    s_cbranch_vccnz C_27
    s_branch R_28
C_29:
    ds_read_b32 v3, v2 offset:2296
    s_sub_u32 s68, s68, 1
    s_cbranch_scc1 L_main_end
    s_waitcnt lgkmcnt(0)
    v_cmp_ne_u32 vcc, 0, v3
    s_cbranch_vccnz C_29
    s_branch R_30
C_31:
    ds_read_b32 v3, v2 offset:2292
    s_sub_u32 s68, s68, 1
    s_cbranch_scc1 L_main_end
    s_waitcnt lgkmcnt(0)
    v_cmp_ne_u32 vcc, 0, v3
    s_cbranch_vccnz C_31
    s_branch R_32
C_33:
    ds_read_b32 v3, v2 offset:2288
    s_sub_u32 s68, s68, 1
    s_cbranch_scc1 L_main_end
    s_waitcnt lgkmcnt(0)
    v_cmp_ne_u32 vcc, 0, v3
    s_cbranch_vccnz C_33
    s_branch R_34
C_35:
    ds_read_b32 v3, v2 offset:2284
    s_sub_u32 s68, s68, 1
    s_cbranch_scc1 L_main_end
    s_waitcnt lgkmcnt(0)
    v_cmp_ne_u32 vcc, 0, v3
    s_cbranch_vccnz C_35
    s_branch R_36
C_37:
    ds_read_b32 v3, v2 offset:2280
    s_sub_u32 s68, s68, 1
    s_cbranch_scc1 L_main_end
    s_waitcnt lgkmcnt(0)
    v_cmp_ne_u32 vcc, 0, v3
    s_cbranch_vccnz C_37
    s_branch R_38
C_39:
    ds_read_b32 v3, v2 offset:2276
    s_sub_u32 s68, s68, 1
    s_cbranch_scc1 L_main_end
    s_waitcnt lgkmcnt(0)
    v_cmp_ne_u32 vcc, 0, v3
    s_cbranch_vccnz C_39
    s_branch R_40
C_41:
G_15:
    s_cbranch_execz G_17
    ds_read_b32 v3, v2 offset:2272
    s_sub_u32 s68, s68, 1
    s_cbranch_scc1 L_main_end
    s_waitcnt lgkmcnt(0)
    v_cmp_ne_u32 vcc, 0, v3
    s_cbranch_vccnz C_41
    s_branch R_42
C_43:
    ds_read_b32 v3, v2 offset:2268
    s_sub_u32 s68, s68, 1
    s_cbranch_scc1 L_main_end
    s_waitcnt lgkmcnt(0)
    v_cmp_ne_u32 vcc, 0, v3
    s_cbranch_vccnz C_43
    s_branch R_44
C_45:
    ds_read_b32 v3, v2 offset:2264
    s_sub_u32 s68, s68, 1
    s_cbranch_scc1 L_main_end
    s_waitcnt lgkmcnt(0)
    v_cmp_ne_u32 vcc, 0, v3
    s_cbranch_vccnz C_45
    s_branch R_46
C_47:
    ds_read_b32 v3, v2 offset:2260
    s_sub_u32 s68, s68, 1
    s_cbranch_scc1 L_main_end
    s_waitcnt lgkmcnt(0)
    v_cmp_ne_u32 vcc, 0, v3
    s_cbranch_vccnz C_47
    s_branch R_48
C_49:
    ds_read_b32 v3, v2 offset:2256
    s_sub_u32 s68, s68, 1
    s_cbranch_scc1 L_main_end
    s_waitcnt lgkmcnt(0)
    v_cmp_ne_u32 vcc, 0, v3
    s_cbranch_vccnz C_49
    s_branch R_50
C_51:
    ds_read_b32 v3, v2 offset:2252
    s_sub_u32 s68, s68, 1
    s_cbranch_scc1 L_main_end
    s_waitcnt lgkmcnt(0)
    v_cmp_ne_u32 vcc, 0, v3
    s_cbranch_vccnz C_51
    s_branch R_52
C_53:
    ds_read_b32 v3, v2 offset:2248
    s_sub_u32 s68, s68, 1
    s_cbranch_scc1 L_main_end
    s_waitcnt lgkmcnt(0)
    v_cmp_ne_u32 vcc, 0, v3
    s_cbranch_vccnz C_53
    s_branch R_54
C_55:
    ds_read_b32 v3, v2 offset:2244
    s_sub_u32 s68, s68, 1
    s_cbranch_scc1 L_main_end
    s_waitcnt lgkmcnt(0)
    v_cmp_ne_u32 vcc, 0, v3
    s_cbranch_vccnz C_55
G_16:
    s_cbranch_execz G_18
    s_branch R_56
C_57:
    ds_read_b32 v3, v2 offset:2240
    s_sub_u32 s68, s68, 1
    s_cbranch_scc1 L_main_end
    s_waitcnt lgkmcnt(0)
    v_cmp_ne_u32 vcc, 0, v3
    s_cbranch_vccnz C_57
    s_branch R_58
C_59:
    ds_read_b32 v3, v2 offset:2236
    s_sub_u32 s68, s68, 1
    s_cbranch_scc1 L_main_end
    s_waitcnt lgkmcnt(0)
    v_cmp_ne_u32 vcc, 0, v3
    s_cbranch_vccnz C_59
    s_branch R_60
C_61:
    ds_read_b32 v3, v2 offset:2232
    s_sub_u32 s68, s68, 1
    s_cbranch_scc1 L_main_end
    s_waitcnt lgkmcnt(0)
    v_cmp_ne_u32 vcc, 0, v3
    s_cbranch_vccnz C_61
    s_branch R_62
C_63:
    ds_read_b32 v4, v2 offset:132
    s_sub_u32 s68, s68, 1
    s_cbranch_scc1 L_main_end
    s_waitcnt lgkmcnt(0)
    v_cmp_ne_u32 vcc, 0, v4
    s_cbranch_vccnz C_63
    s_branch R_64
C_65:
    ds_read_b32 v3, v2 offset:2228
    s_sub_u32 s68, s68, 1
    s_cbranch_scc1 L_main_end
    s_waitcnt lgkmcnt(0)
    v_cmp_ne_u32 vcc, 0, v3
    s_cbranch_vccnz C_65
    s_branch R_66
C_67:
    ds_read_b32 v3, v2 offset:2224
    s_sub_u32 s68, s68, 1
    s_cbranch_scc1 L_main_end
    s_waitcnt lgkmcnt(0)
    v_cmp_ne_u32 vcc, 0, v3
    s_cbranch_vccnz C_67
    s_branch R_68
C_69:
    ds_read_b32 v4, v2 offset:4224
    s_sub_u32 s68, s68, 1
    s_cbranch_scc1 L_main_end
    s_waitcnt lgkmcnt(0)
    v_cmp_gt_u32 vcc, 1, v4
    s_cbranch_vccnz C_69
    s_branch R_70
C_71:
    ds_read_b32 v3, v2 offset:2220
    s_sub_u32 s68, s68, 1
    s_cbranch_scc1 L_main_end
    s_waitcnt lgkmcnt(0)
    v_cmp_ne_u32 vcc, 0, v3
G_17:
    s_cbranch_execz G_19
    s_cbranch_vccnz C_71
    s_branch R_72
C_73:
    ds_read_b32 v3, v2 offset:2216
    s_sub_u32 s68, s68, 1
    s_cbranch_scc1 L_main_end
    s_waitcnt lgkmcnt(0)
    v_cmp_ne_u32 vcc, 0, v3
    s_cbranch_vccnz C_73
    s_branch R_74
C_75:
    ds_read_b32 v3, v2 offset:2212
    s_sub_u32 s68, s68, 1
    s_cbranch_scc1 L_main_end
    s_waitcnt lgkmcnt(0)
    v_cmp_ne_u32 vcc, 0, v3
    s_cbranch_vccnz C_75
    s_branch R_76
C_77:
    ds_read_b32 v3, v2 offset:2204
    s_sub_u32 s68, s68, 1
    s_cbranch_scc1 L_main_end
    s_waitcnt lgkmcnt(0)
    v_cmp_ne_u32 vcc, 0, v3
    s_cbranch_vccnz C_77
    s_branch R_78
C_79:
    ds_read_b32 v3, v2 offset:2200
    s_sub_u32 s68, s68, 1
    s_cbranch_scc1 L_main_end
    s_waitcnt lgkmcnt(0)
    v_cmp_ne_u32 vcc, 0, v3
    s_cbranch_vccnz C_79
    s_branch R_80
C_81:
    ds_read_b32 v3, v2 offset:2196
    s_sub_u32 s68, s68, 1
    s_cbranch_scc1 L_main_end
    s_waitcnt lgkmcnt(0)
    v_cmp_ne_u32 vcc, 0, v3
    s_cbranch_vccnz C_81
    s_branch R_82
C_83:
    ds_read_b32 v3, v2 offset:2192
    s_sub_u32 s68, s68, 1
    s_cbranch_scc1 L_main_end
    s_waitcnt lgkmcnt(0)
    v_cmp_ne_u32 vcc, 0, v3
    s_cbranch_vccnz C_83
    s_branch R_84
L_code_end:
.section .rodata,"a"
.p2align 6
.amdhsa_kernel standalone__gqa_block_cached__near_ridge_kernel
  .amdhsa_next_free_vgpr 256
  .amdhsa_next_free_sgpr 100
  .amdhsa_accum_offset 256
  .amdhsa_group_segment_fixed_size 0
  .amdhsa_kernarg_size 64
  .amdhsa_user_sgpr_count 2
  .amdhsa_user_sgpr_kernarg_segment_ptr 1
  .amdhsa_system_sgpr_workgroup_id_x 1
  .amdhsa_float_denorm_mode_32 3
.end_amdhsa_kernel
```
